```python
import torch

def _softmax(x, axis=-1):
    return torch.softmax(x, dim=axis)
def _gelu(x):
    return torch.nn.functional.gelu(x, approximate="tanh")
def _silu(x):
    return torch.nn.functional.silu(x)
def _sigmoid(x):
    return torch.sigmoid(x)
def _layernorm(x, axis=-1, eps=1e-5):
    m = x.mean(dim=axis, keepdim=True)
    v = x.var(dim=axis, keepdim=True, unbiased=False)
    return (x - m) / torch.sqrt(v + eps)
def _scatter_add(tgt, idx, src, axis=0):
    return tgt.clone().index_add_(axis, idx, src)
def _segment_sum(src, seg, n):
    out = torch.zeros((n,) + src.shape[1:], dtype=src.dtype)
    return out.index_add_(0, seg, src)
def _pad(x, pw):
    flat = tuple(v for pair in reversed(pw) for v in pair)
    return torch.nn.functional.pad(x, flat)

kernel_name = 'concat_heads__linear_attn_block__ssm_conv_s4d__prompt'

def setup_inputs():

    _w = (lambda a: (lambda t: t.to(torch.bfloat16) if t.is_floating_point() else t)(torch.as_tensor(a)))
    def _A_setup():
        B, S, D = 1, 2048, 640
        return {
            "x": _w((lambda *s: torch.randn(*s, dtype=torch.bfloat16) * 0.05)(B, S, D)),
            "wqkv": _w((lambda *s: torch.randn(*s, dtype=torch.bfloat16) * 0.4)(D, 3 * D)),
            "wo": _w((lambda *s: torch.randn(*s, dtype=torch.bfloat16) * 0.05)(D, D)),
        }
    _A_in = _A_setup()

    def _B_setup():
        Bsz, L, D, N = 1, 2048, 640, 192
        return {
            "u": _w((lambda *s: torch.randn(*s, dtype=torch.bfloat16) * 0.05)(Bsz, L, D)),
            "log_A_real": _w((lambda *s: torch.randn(*s, dtype=torch.bfloat16) * 6.4)(D, N) * 0.5),
            "A_imag": _w((lambda *s: torch.randn(*s, dtype=torch.bfloat16) * 0.05)(D, N) * 3.14),
            "C_real": _w((lambda *s: torch.randn(*s, dtype=torch.bfloat16) * 0.1)(D, N) / N ** 0.5),
            "C_imag": _w((lambda *s: torch.randn(*s, dtype=torch.bfloat16) * 0.1)(D, N) / N ** 0.5),
            "log_dt": _w((lambda *s: torch.randn(*s, dtype=torch.bfloat16) * 0.05)(D) * 0.5 - 4.0),
            "D_skip": _w((lambda *s: torch.randn(*s, dtype=torch.bfloat16) * 0.05)(D)),
        }
    _B_in = _B_setup()

    return {
        "A_x": _A_in["x"],
        "A_wqkv": _A_in["wqkv"],
        "A_wo": _A_in["wo"],
        "B_u": _B_in["u"],
        "B_log_A_real": _B_in["log_A_real"],
        "B_A_imag": _B_in["A_imag"],
        "B_C_real": _B_in["C_real"],
        "B_C_imag": _B_in["C_imag"],
        "B_log_dt": _B_in["log_dt"],
        "B_D_skip": _B_in["D_skip"],
    }

def reference(A_x, A_wqkv, A_wo, B_u, B_log_A_real, B_A_imag, B_C_real, B_C_imag, B_log_dt, B_D_skip):
    def _A_ref(x, wqkv, wo):
        B, S, D = x.shape
        H = 32; Dh = D // H
        qkv = (lambda x, *d: x.permute(*d))((x @ wqkv).reshape(B, S, 3, H, Dh), 2, 0, 3, 1, 4)
        q, k, v = qkv[0], qkv[1], qkv[2]
        phi = lambda t: torch.where(t > 0, t + 1, torch.exp(t)) + 1e-6
        pq, pk = phi(q), phi(k)
        kv = torch.einsum("bhsd,bhse->bhde", pk, v)
        z = torch.einsum("bhsd->bhd", pk)
        num = torch.einsum("bhqd,bhde->bhqe", pq, kv)
        den = torch.einsum("bhqd,bhd->bhq", pq, z)[..., None] + 1e-6
        o = num / den
        return (lambda x, *d: x.permute(*d))(o, 0, 2, 1, 3).reshape(B, S, D) @ wo

    def _B_ref(u, log_A_real, A_imag, C_real, C_imag, log_dt, D_skip):
        L = u.shape[1]
        dt = torch.exp(log_dt)
        A = -torch.exp(log_A_real) + 1j * A_imag
        C = (C_real + 1j * C_imag) * dt[:, None]
        pos = (lambda x, dt: x.to(dt))(torch.arange(L), log_dt.dtype)
        P = torch.exp((A * dt[:, None])[:, :, None] * pos[None, None, :])
        K = 2.0 * torch.einsum("dn,dnl->dl", C, P).real
        L2 = 2 * L
        u_t = (lambda x, *d: x.permute(*d))(u, 0, 2, 1)
        Kf = (lambda x, *a, **k: torch.fft.rfft(x.float(), *a, **k))(K, L2)
        Uf = (lambda x, *a, **k: torch.fft.rfft(x.float(), *a, **k))(u_t, L2)
        y = (lambda x, *a, **k: torch.fft.irfft(x, *a, **k).to(torch.bfloat16))(Uf * Kf[None, :, :], L2)[:, :, :L]
        y = (lambda x, *d: x.permute(*d))(y, 0, 2, 1)
        return y + u * D_skip[None, None, :]

    a = _A_ref(A_x, A_wqkv, A_wo)
    b = _B_ref(B_u, B_log_A_real, B_A_imag, B_C_real, B_C_imag, B_log_dt, B_D_skip)
    return torch.concatenate([a, b], axis=-1)
```

```asm
; @launch kernel=k1_kernel grid=(672,1,1) block=(512,1,1) lds=77824
; @launch kernel=k2_kernel grid=(672,1,1) block=(256,1,1) lds=44544
; @launch kernel=k3_kernel grid=(240,1,1) block=(512,1,1) lds=83200
.amdgcn_target "amdgcn-amd-amdhsa--gfx950"
.text
.globl k1_kernel
.p2align 8
.type k1_kernel,@function
k1_kernel:
    s_cmp_ge_u32 s2, 672
    s_cbranch_scc1 L_k1_exit
    s_cmp_ge_u32 s2, 512
    s_cbranch_scc1 L_k1_c
    s_cmp_ge_u32 s2, 256
    s_cbranch_scc1 L_k1_b
    s_sub_u32 s3, s2, 0
    s_load_dwordx8 s[8:15], s[0:1], 32
    s_load_dwordx2 s[16:17], s[0:1], 64
    s_load_dwordx2 s[18:19], s[0:1], 96
    v_lshrrev_b32 v4, 6, v0
    s_nop 0
    v_readfirstlane_b32 s4, v4
    v_and_b32 v1, 63, v0
    v_and_b32 v2, 15, v0
    v_bfe_u32 v3, v0, 4, 2
    s_lshr_b32 s5, s4, 1
    s_and_b32 s4, s4, 1
    s_lshl_b32 s6, s5, 8
    s_add_u32 s3, s3, s6
    s_cmp_ge_u32 s3, 640
    s_cbranch_scc1 L_kgen_exit
    s_mul_i32 s5, s5, 12288
    s_mul_i32 s44, s3, 384
    s_mul_i32 s6, s4, 192
    s_add_u32 s44, s44, s6
    s_lshl_b32 s45, s3, 1
    s_and_b32 s45, s45, 0xfffffffc
    v_lshlrev_b32 v5, 2, v1
    v_min_u32 v5, 188, v5
    s_waitcnt lgkmcnt(0)
    s_mov_b32 s20, s8
    s_mov_b32 s21, s9
    s_mov_b32 s22, 245760
    s_mov_b32 s23, 0x00020000
    s_mov_b32 s24, s10
    s_mov_b32 s25, s11
    s_mov_b32 s26, 245760
    s_mov_b32 s27, 0x00020000
    s_mov_b32 s28, s12
    s_mov_b32 s29, s13
    s_mov_b32 s30, 245760
    s_mov_b32 s31, 0x00020000
    s_mov_b32 s32, s14
    s_mov_b32 s33, s15
    s_mov_b32 s34, 245760
    s_mov_b32 s35, 0x00020000
    s_mov_b32 s40, s18
    s_mov_b32 s41, s19
    s_mov_b32 s42, 16777216
    s_mov_b32 s43, 0x00020000
    buffer_load_dword v16, v5, s[20:23], s44 offen
    buffer_load_dword v17, v5, s[24:27], s44 offen
    buffer_load_dword v18, v5, s[28:31], s44 offen
    buffer_load_dword v19, v5, s[32:35], s44 offen
    s_load_dword s51, s[16:17], s45
    v_and_b32 v35, 7, v2
    v_and_b32 v52, 8, v2
    v_lshlrev_b32 v52, 4, v52
    v_or_b32 v35, v35, v52
    v_and_b32 v52, 4, v2
    v_lshlrev_b32 v52, 5, v52
    v_and_b32 v53, 3, v2
    v_lshlrev_b32 v53, 1, v53
    v_add3_u32 v36, v52, v53, 0
    v_add_u32 v36, 0x100, v36
    v_and_b32 v52, 6, v2
    v_lshlrev_b32 v52, 6, v52
    v_and_b32 v53, 1, v2
    v_lshlrev_b32 v53, 2, v53
    v_add_u32 v52, v52, v53
    v_add_u32 v52, 0x200, v52
    v_cmp_gt_u32 vcc, 8, v2
    s_nop 1
    v_cndmask_b32 v36, v52, v36, vcc
    v_lshlrev_b32 v52, 7, v2
    v_add_u32 v52, 0x400, v52
    v_mov_b32 v53, 0x800
    v_cndmask_b32 v37, v53, v52, vcc
    v_lshlrev_b32 v34, 3, v2
    v_cvt_f32_u32 v34, v34
    v_cvt_f32_u32 v35, v35
    v_cvt_f32_u32 v36, v36
    v_cvt_f32_u32 v37, v37
    v_mov_b32 v40, 0
    v_mov_b32 v41, 0
    v_mov_b32 v42, 0
    v_mov_b32 v43, 0
    v_mov_b32 v44, 0
    v_mov_b32 v45, 0
    v_mov_b32 v46, 0
    v_mov_b32 v47, 0
    v_mov_b32 v48, 0
    v_mov_b32 v49, 0
    v_mov_b32 v50, 0
    v_mov_b32 v51, 0
    v_mov_b32 v52, 0
    v_mov_b32 v53, s5
    ds_write_b16 v53, v52 offset:4400
    s_mov_b32 s46, 0x3fb8aa3b
    s_mov_b32 s47, 0xbfb8aa3b
    s_mov_b32 s48, 0xffff0000
    s_mul_i32 s6, s4, 1536
    s_add_u32 s6, s6, s5
    v_lshlrev_b32 v13, 5, v1
    v_add_u32 v13, s6, v13
    v_mul_u32_u24 v12, 384, v3
    v_add_u32 v12, s6, v12
    s_waitcnt lgkmcnt(0)
    s_and_b32 s7, s3, 1
    s_lshl_b32 s7, s7, 4
    s_lshr_b32 s51, s51, s7
    s_lshl_b32 s51, s51, 16
    v_mov_b32 v32, s51
    v_mul_f32 v32, s46, v32
    v_exp_f32 v32, v32
    s_nop 0
    v_cvt_pk_bf16_f32 v32, v32, v32
    v_lshlrev_b32 v32, 16, v32
    v_add_f32 v33, v32, v32
    s_waitcnt vmcnt(0)
    s_mov_b32 s52, 0x3e22f982
    s_mov_b32 s53, 0xbd594a64
    s_mov_b32 s54, 0x3d022dde
    s_mov_b32 s55, 0xbcb6bf74
    s_mov_b32 s56, 0x3c8127ca
    s_mov_b32 s57, 0xbc1ace2a
    s_mov_b32 s58, 0x3b7c1000
    v_lshlrev_b32 v56, 16, v16
    v_and_b32 v72, s48, v16
    v_lshlrev_b32 v57, 16, v17
    v_and_b32 v73, s48, v17
    v_lshlrev_b32 v58, 16, v18
    v_and_b32 v74, s48, v18
    v_lshlrev_b32 v59, 16, v19
    v_and_b32 v75, s48, v19
    v_mul_f32 v56, s46, v56
    v_mul_f32 v72, s46, v72
    v_exp_f32 v56, v56
    v_exp_f32 v72, v72
    v_mul_f32 v57, v57, v32
    v_mul_f32 v73, v73, v32
    v_mul_f32 v58, v58, v33
    v_mul_f32 v74, v74, v33
    v_cvt_pk_bf16_f32 v56, v56, v56
    v_cvt_pk_bf16_f32 v72, v72, v72
    v_mul_f32 v59, v59, v33
    v_mul_f32 v75, v75, v33
    v_lshlrev_b32 v56, 16, v56
    v_lshlrev_b32 v72, 16, v72
    v_mul_f32 v57, 0.15915494, v57
    v_mul_f32 v73, 0.15915494, v73
    v_mul_f32 v56, v56, v32
    v_mul_f32 v72, v72, v32
    v_mul_f32 v56, s47, v56
    v_mul_f32 v72, s47, v72
    v_mul_f32 v60, v58, v58
    v_mul_f32 v76, v74, v74
    v_fma_f32 v60, v59, v59, v60
    v_fma_f32 v76, v75, v75, v76
    v_log_f32 v60, v60
    v_log_f32 v76, v76
    v_max_f32 v62, abs(v58), abs(v59)
    v_max_f32 v78, abs(v74), abs(v75)
    v_min_f32 v63, abs(v58), abs(v59)
    v_min_f32 v79, abs(v74), abs(v75)
    v_max_f32 v62, 0x00800000, v62
    v_max_f32 v78, 0x00800000, v78
    v_rcp_f32 v62, v62
    v_rcp_f32 v78, v78
    v_mul_f32 v60, 0.5, v60
    v_mul_f32 v76, 0.5, v76
    v_mul_f32 v63, v63, v62
    v_mul_f32 v79, v79, v78
    v_mul_f32 v62, v63, v63
    v_mul_f32 v78, v79, v79
    v_mov_b32 v61, 0xba42c9cd
    v_mov_b32 v77, 0xba42c9cd
    v_fma_f32 v61, v61, v62, s58
    v_fma_f32 v77, v77, v78, s58
    v_fma_f32 v61, v61, v62, s57
    v_fma_f32 v77, v77, v78, s57
    v_fma_f32 v61, v61, v62, s56
    v_fma_f32 v77, v77, v78, s56
    v_fma_f32 v61, v61, v62, s55
    v_fma_f32 v77, v77, v78, s55
    v_fma_f32 v61, v61, v62, s54
    v_fma_f32 v77, v77, v78, s54
    v_fma_f32 v61, v61, v62, s53
    v_fma_f32 v77, v77, v78, s53
    v_fma_f32 v61, v61, v62, s52
    v_fma_f32 v77, v77, v78, s52
    v_mul_f32 v61, v61, v63
    v_mul_f32 v77, v77, v79
    v_sub_f32 v62, 0.25, v61
    v_sub_f32 v78, 0.25, v77
    v_cmp_gt_f32 s[60:61], abs(v59), abs(v58)
    v_cmp_gt_f32 s[62:63], abs(v75), abs(v74)
    s_nop 0
    v_cndmask_b32 v61, v61, v62, s[60:61]
    v_cndmask_b32 v77, v77, v78, s[62:63]
    v_sub_f32 v62, 0.5, v61
    v_sub_f32 v78, 0.5, v77
    v_cmp_gt_f32 s[60:61], 0, v58
    v_cmp_gt_f32 s[62:63], 0, v74
    s_nop 0
    v_cndmask_b32 v61, v61, v62, s[60:61]
    v_cndmask_b32 v77, v77, v78, s[62:63]
    v_cmp_gt_f32 s[60:61], 0, v59
    v_cmp_gt_f32 s[62:63], 0, v75
    s_nop 0
    v_cndmask_b32 v59, v61, -v61, s[60:61]
    v_cndmask_b32 v75, v77, -v77, s[62:63]
    v_mov_b32 v58, v60
    v_mov_b32 v74, v76
    v_cmp_gt_u32 vcc, 48, v1
    s_nop 0
    s_and_saveexec_b64 s[22:23], vcc
    ds_write_b128 v13, v[56:59] offset:4608
    ds_write_b128 v13, v[72:75] offset:4624
    s_mov_b64 exec, s[22:23]
    s_mov_b32 s49, 0
L_kgen_cl:
    ds_read_b128 v[96:99], v12 offset:4608
    ds_read_b128 v[100:103], v12 offset:4624
    ds_read_b128 v[104:107], v12 offset:4640
    ds_read_b128 v[108:111], v12 offset:4656
    ds_read_b128 v[112:115], v12 offset:4672
    ds_read_b128 v[116:119], v12 offset:4688
    ds_read_b128 v[120:123], v12 offset:4704
    ds_read_b128 v[124:127], v12 offset:4720
    v_add_u32 v12, 128, v12
    s_waitcnt lgkmcnt(4)
    v_mul_f32 v52, v96, v34
    v_mul_f32 v68, v100, v34
    v_mul_f32 v53, v97, v34
    v_mul_f32 v69, v101, v34
    v_fma_f32 v56, v96, v35, v98
    v_fma_f32 v72, v100, v35, v102
    v_fma_f32 v57, v97, v35, v99
    v_fma_f32 v73, v101, v35, v103
    v_fma_f32 v60, v96, v36, v98
    v_fma_f32 v76, v100, v36, v102
    v_fma_f32 v61, v97, v36, v99
    v_fma_f32 v77, v101, v36, v103
    v_fma_f32 v64, v96, v37, v98
    v_fma_f32 v80, v100, v37, v102
    v_fma_f32 v65, v97, v37, v99
    v_fma_f32 v81, v101, v37, v103
    v_exp_f32 v52, v52
    v_exp_f32 v68, v68
    v_fract_f32 v53, v53
    v_fract_f32 v69, v69
    v_exp_f32 v56, v56
    v_exp_f32 v72, v72
    v_fract_f32 v57, v57
    v_fract_f32 v73, v73
    v_exp_f32 v60, v60
    v_exp_f32 v76, v76
    v_fract_f32 v61, v61
    v_fract_f32 v77, v77
    v_exp_f32 v64, v64
    v_exp_f32 v80, v80
    v_fract_f32 v65, v65
    v_fract_f32 v81, v81
    v_cos_f32 v54, v53
    v_cos_f32 v70, v69
    v_sin_f32 v55, v53
    v_sin_f32 v71, v69
    v_cos_f32 v58, v57
    v_cos_f32 v74, v73
    v_sin_f32 v59, v57
    v_sin_f32 v75, v73
    v_cos_f32 v62, v61
    v_cos_f32 v78, v77
    v_sin_f32 v63, v61
    v_sin_f32 v79, v77
    v_cos_f32 v66, v65
    v_cos_f32 v82, v81
    v_sin_f32 v67, v65
    v_sin_f32 v83, v81
    v_mul_f32 v54, v52, v54
    v_mul_f32 v70, v68, v70
    v_mul_f32 v55, v52, v55
    v_mul_f32 v71, v68, v71
    v_mul_f32 v58, v56, v58
    v_mul_f32 v74, v72, v74
    v_mul_f32 v59, v56, v59
    v_mul_f32 v75, v72, v75
    v_mul_f32 v62, v60, v62
    v_mul_f32 v78, v76, v78
    v_mul_f32 v63, v60, v63
    v_mul_f32 v79, v76, v79
    v_mul_f32 v66, v64, v66
    v_mul_f32 v82, v80, v82
    v_mul_f32 v67, v64, v67
    v_mul_f32 v83, v80, v83
    v_cvt_pk_bf16_f32 v28, v54, -v55
    v_cvt_pk_bf16_f32 v29, v70, -v71
    v_cvt_pk_bf16_f32 v16, v58, v59
    v_cvt_pk_bf16_f32 v17, v74, v75
    v_cvt_pk_bf16_f32 v20, v62, v63
    v_cvt_pk_bf16_f32 v21, v78, v79
    v_cvt_pk_bf16_f32 v24, v66, v67
    v_cvt_pk_bf16_f32 v25, v82, v83
    v_mul_f32 v52, v104, v34
    v_mul_f32 v68, v108, v34
    v_mul_f32 v53, v105, v34
    v_mul_f32 v69, v109, v34
    v_fma_f32 v56, v104, v35, v106
    v_fma_f32 v72, v108, v35, v110
    v_fma_f32 v57, v105, v35, v107
    v_fma_f32 v73, v109, v35, v111
    v_fma_f32 v60, v104, v36, v106
    v_fma_f32 v76, v108, v36, v110
    v_fma_f32 v61, v105, v36, v107
    v_fma_f32 v77, v109, v36, v111
    v_fma_f32 v64, v104, v37, v106
    v_fma_f32 v80, v108, v37, v110
    v_fma_f32 v65, v105, v37, v107
    v_fma_f32 v81, v109, v37, v111
    v_exp_f32 v52, v52
    v_exp_f32 v68, v68
    v_fract_f32 v53, v53
    v_fract_f32 v69, v69
    v_exp_f32 v56, v56
    v_exp_f32 v72, v72
    v_fract_f32 v57, v57
    v_fract_f32 v73, v73
    v_exp_f32 v60, v60
    v_exp_f32 v76, v76
    v_fract_f32 v61, v61
    v_fract_f32 v77, v77
    v_exp_f32 v64, v64
    v_exp_f32 v80, v80
    v_fract_f32 v65, v65
    v_fract_f32 v81, v81
    v_cos_f32 v54, v53
    v_cos_f32 v70, v69
    v_sin_f32 v55, v53
    v_sin_f32 v71, v69
    v_cos_f32 v58, v57
    v_cos_f32 v74, v73
    v_sin_f32 v59, v57
    v_sin_f32 v75, v73
    v_cos_f32 v62, v61
    v_cos_f32 v78, v77
    v_sin_f32 v63, v61
    v_sin_f32 v79, v77
    v_cos_f32 v66, v65
    v_cos_f32 v82, v81
    v_sin_f32 v67, v65
    v_sin_f32 v83, v81
    v_mul_f32 v54, v52, v54
    v_mul_f32 v70, v68, v70
    v_mul_f32 v55, v52, v55
    v_mul_f32 v71, v68, v71
    v_mul_f32 v58, v56, v58
    v_mul_f32 v74, v72, v74
    v_mul_f32 v59, v56, v59
    v_mul_f32 v75, v72, v75
    v_mul_f32 v62, v60, v62
    v_mul_f32 v78, v76, v78
    v_mul_f32 v63, v60, v63
    v_mul_f32 v79, v76, v79
    v_mul_f32 v66, v64, v66
    v_mul_f32 v82, v80, v82
    v_mul_f32 v67, v64, v67
    v_mul_f32 v83, v80, v83
    v_cvt_pk_bf16_f32 v30, v54, -v55
    v_cvt_pk_bf16_f32 v31, v70, -v71
    v_cvt_pk_bf16_f32 v18, v58, v59
    v_cvt_pk_bf16_f32 v19, v74, v75
    v_cvt_pk_bf16_f32 v22, v62, v63
    v_cvt_pk_bf16_f32 v23, v78, v79
    v_cvt_pk_bf16_f32 v26, v66, v67
    v_cvt_pk_bf16_f32 v27, v82, v83
    v_mfma_f32_16x16x32_bf16 v[40:43], v[16:19], v[28:31], v[40:43]
    v_mfma_f32_16x16x32_bf16 v[44:47], v[20:23], v[28:31], v[44:47]
    v_mfma_f32_16x16x32_bf16 v[48:51], v[24:27], v[28:31], v[48:51]
    s_waitcnt lgkmcnt(0)
    v_mul_f32 v52, v112, v34
    v_mul_f32 v68, v116, v34
    v_mul_f32 v53, v113, v34
    v_mul_f32 v69, v117, v34
    v_fma_f32 v56, v112, v35, v114
    v_fma_f32 v72, v116, v35, v118
    v_fma_f32 v57, v113, v35, v115
    v_fma_f32 v73, v117, v35, v119
    v_fma_f32 v60, v112, v36, v114
    v_fma_f32 v76, v116, v36, v118
    v_fma_f32 v61, v113, v36, v115
    v_fma_f32 v77, v117, v36, v119
    v_fma_f32 v64, v112, v37, v114
    v_fma_f32 v80, v116, v37, v118
    v_fma_f32 v65, v113, v37, v115
    v_fma_f32 v81, v117, v37, v119
    v_exp_f32 v52, v52
    v_exp_f32 v68, v68
    v_fract_f32 v53, v53
    v_fract_f32 v69, v69
    v_exp_f32 v56, v56
    v_exp_f32 v72, v72
    v_fract_f32 v57, v57
    v_fract_f32 v73, v73
    v_exp_f32 v60, v60
    v_exp_f32 v76, v76
    v_fract_f32 v61, v61
    v_fract_f32 v77, v77
    v_exp_f32 v64, v64
    v_exp_f32 v80, v80
    v_fract_f32 v65, v65
    v_fract_f32 v81, v81
    v_cos_f32 v54, v53
    v_cos_f32 v70, v69
    v_sin_f32 v55, v53
    v_sin_f32 v71, v69
    v_cos_f32 v58, v57
    v_cos_f32 v74, v73
    v_sin_f32 v59, v57
    v_sin_f32 v75, v73
    v_cos_f32 v62, v61
    v_cos_f32 v78, v77
    v_sin_f32 v63, v61
    v_sin_f32 v79, v77
    v_cos_f32 v66, v65
    v_cos_f32 v82, v81
    v_sin_f32 v67, v65
    v_sin_f32 v83, v81
    v_mul_f32 v54, v52, v54
    v_mul_f32 v70, v68, v70
    v_mul_f32 v55, v52, v55
    v_mul_f32 v71, v68, v71
    v_mul_f32 v58, v56, v58
    v_mul_f32 v74, v72, v74
    v_mul_f32 v59, v56, v59
    v_mul_f32 v75, v72, v75
    v_mul_f32 v62, v60, v62
    v_mul_f32 v78, v76, v78
    v_mul_f32 v63, v60, v63
    v_mul_f32 v79, v76, v79
    v_mul_f32 v66, v64, v66
    v_mul_f32 v82, v80, v82
    v_mul_f32 v67, v64, v67
    v_mul_f32 v83, v80, v83
    v_cvt_pk_bf16_f32 v28, v54, -v55
    v_cvt_pk_bf16_f32 v29, v70, -v71
    v_cvt_pk_bf16_f32 v16, v58, v59
    v_cvt_pk_bf16_f32 v17, v74, v75
    v_cvt_pk_bf16_f32 v20, v62, v63
    v_cvt_pk_bf16_f32 v21, v78, v79
    v_cvt_pk_bf16_f32 v24, v66, v67
    v_cvt_pk_bf16_f32 v25, v82, v83
    v_mul_f32 v52, v120, v34
    v_mul_f32 v68, v124, v34
    v_mul_f32 v53, v121, v34
    v_mul_f32 v69, v125, v34
    v_fma_f32 v56, v120, v35, v122
    v_fma_f32 v72, v124, v35, v126
    v_fma_f32 v57, v121, v35, v123
    v_fma_f32 v73, v125, v35, v127
    v_fma_f32 v60, v120, v36, v122
    v_fma_f32 v76, v124, v36, v126
    v_fma_f32 v61, v121, v36, v123
    v_fma_f32 v77, v125, v36, v127
    v_fma_f32 v64, v120, v37, v122
    v_fma_f32 v80, v124, v37, v126
    v_fma_f32 v65, v121, v37, v123
    v_fma_f32 v81, v125, v37, v127
    v_exp_f32 v52, v52
    v_exp_f32 v68, v68
    v_fract_f32 v53, v53
    v_fract_f32 v69, v69
    v_exp_f32 v56, v56
    v_exp_f32 v72, v72
    v_fract_f32 v57, v57
    v_fract_f32 v73, v73
    v_exp_f32 v60, v60
    v_exp_f32 v76, v76
    v_fract_f32 v61, v61
    v_fract_f32 v77, v77
    v_exp_f32 v64, v64
    v_exp_f32 v80, v80
    v_fract_f32 v65, v65
    v_fract_f32 v81, v81
    v_cos_f32 v54, v53
    v_cos_f32 v70, v69
    v_sin_f32 v55, v53
    v_sin_f32 v71, v69
    v_cos_f32 v58, v57
    v_cos_f32 v74, v73
    v_sin_f32 v59, v57
    v_sin_f32 v75, v73
    v_cos_f32 v62, v61
    v_cos_f32 v78, v77
    v_sin_f32 v63, v61
    v_sin_f32 v79, v77
    v_cos_f32 v66, v65
    v_cos_f32 v82, v81
    v_sin_f32 v67, v65
    v_sin_f32 v83, v81
    v_mul_f32 v54, v52, v54
    v_mul_f32 v70, v68, v70
    v_mul_f32 v55, v52, v55
    v_mul_f32 v71, v68, v71
    v_mul_f32 v58, v56, v58
    v_mul_f32 v74, v72, v74
    v_mul_f32 v59, v56, v59
    v_mul_f32 v75, v72, v75
    v_mul_f32 v62, v60, v62
    v_mul_f32 v78, v76, v78
    v_mul_f32 v63, v60, v63
    v_mul_f32 v79, v76, v79
    v_mul_f32 v66, v64, v66
    v_mul_f32 v82, v80, v82
    v_mul_f32 v67, v64, v67
    v_mul_f32 v83, v80, v83
    v_cvt_pk_bf16_f32 v30, v54, -v55
    v_cvt_pk_bf16_f32 v31, v70, -v71
    v_cvt_pk_bf16_f32 v18, v58, v59
    v_cvt_pk_bf16_f32 v19, v74, v75
    v_cvt_pk_bf16_f32 v22, v62, v63
    v_cvt_pk_bf16_f32 v23, v78, v79
    v_cvt_pk_bf16_f32 v26, v66, v67
    v_cvt_pk_bf16_f32 v27, v82, v83
    v_mfma_f32_16x16x32_bf16 v[40:43], v[16:19], v[28:31], v[40:43]
    v_mfma_f32_16x16x32_bf16 v[44:47], v[20:23], v[28:31], v[44:47]
    v_mfma_f32_16x16x32_bf16 v[48:51], v[24:27], v[28:31], v[48:51]
    s_add_u32 s49, s49, 1
    s_cmp_lt_u32 s49, 3
    s_cbranch_scc1 L_kgen_cl
    s_nop 7
    v_lshlrev_b32 v52, 4, v1
    v_add_u32 v52, s5, v52
    s_cmp_eq_u32 s4, 0
    s_cbranch_scc1 L_kgen_h0a
    ds_write_b128 v52, v[40:43] offset:8192
    ds_write_b128 v52, v[44:47] offset:9216
    ds_write_b128 v52, v[48:51] offset:10240
L_kgen_h0a:
    s_waitcnt lgkmcnt(0)
    s_barrier
    s_cmp_eq_u32 s4, 1
    s_cbranch_scc1 L_kgen_h1b
    ds_read_b128 v[56:59], v52 offset:8192
    ds_read_b128 v[60:63], v52 offset:9216
    ds_read_b128 v[64:67], v52 offset:10240
    v_lshlrev_b32 v54, 3, v2
    v_lshl_add_u32 v53, v3, 2, 0
    v_and_b32 v72, 7, v53
    v_and_b32 v84, 8, v53
    v_lshlrev_b32 v84, 4, v84
    v_or_b32 v72, v72, v84
    v_and_b32 v84, 4, v53
    v_lshlrev_b32 v84, 5, v84
    v_and_b32 v85, 3, v53
    v_lshlrev_b32 v85, 1, v85
    v_add3_u32 v76, v84, v85, 0
    v_add_u32 v76, 0x100, v76
    v_and_b32 v84, 6, v53
    v_lshlrev_b32 v84, 6, v84
    v_and_b32 v85, 1, v53
    v_lshlrev_b32 v85, 2, v85
    v_add_u32 v84, v84, v85
    v_add_u32 v84, 0x200, v84
    v_cmp_gt_u32 vcc, 8, v53
    s_nop 1
    v_cndmask_b32 v76, v84, v76, vcc
    v_lshlrev_b32 v84, 7, v53
    v_add_u32 v84, 0x400, v84
    v_mov_b32 v85, 0x800
    v_cndmask_b32 v80, v85, v84, vcc
    v_add_lshl_u32 v72, v72, v54, 1
    v_add_u32 v72, s5, v72
    v_add_lshl_u32 v76, v76, v54, 1
    v_add_u32 v76, s5, v76
    v_add_lshl_u32 v80, v80, v54, 1
    v_add_u32 v80, s5, v80
    v_lshl_add_u32 v53, v3, 2, 1
    v_and_b32 v73, 7, v53
    v_and_b32 v84, 8, v53
    v_lshlrev_b32 v84, 4, v84
    v_or_b32 v73, v73, v84
    v_and_b32 v84, 4, v53
    v_lshlrev_b32 v84, 5, v84
    v_and_b32 v85, 3, v53
    v_lshlrev_b32 v85, 1, v85
    v_add3_u32 v77, v84, v85, 0
    v_add_u32 v77, 0x100, v77
    v_and_b32 v84, 6, v53
    v_lshlrev_b32 v84, 6, v84
    v_and_b32 v85, 1, v53
    v_lshlrev_b32 v85, 2, v85
    v_add_u32 v84, v84, v85
    v_add_u32 v84, 0x200, v84
    v_cmp_gt_u32 vcc, 8, v53
    s_nop 1
    v_cndmask_b32 v77, v84, v77, vcc
    v_lshlrev_b32 v84, 7, v53
    v_add_u32 v84, 0x400, v84
    v_mov_b32 v85, 0x800
    v_cndmask_b32 v81, v85, v84, vcc
    v_add_lshl_u32 v73, v73, v54, 1
    v_add_u32 v73, s5, v73
    v_add_lshl_u32 v77, v77, v54, 1
    v_add_u32 v77, s5, v77
    v_add_lshl_u32 v81, v81, v54, 1
    v_add_u32 v81, s5, v81
    v_lshl_add_u32 v53, v3, 2, 2
    v_and_b32 v74, 7, v53
    v_and_b32 v84, 8, v53
    v_lshlrev_b32 v84, 4, v84
    v_or_b32 v74, v74, v84
    v_and_b32 v84, 4, v53
    v_lshlrev_b32 v84, 5, v84
    v_and_b32 v85, 3, v53
    v_lshlrev_b32 v85, 1, v85
    v_add3_u32 v78, v84, v85, 0
    v_add_u32 v78, 0x100, v78
    v_and_b32 v84, 6, v53
    v_lshlrev_b32 v84, 6, v84
    v_and_b32 v85, 1, v53
    v_lshlrev_b32 v85, 2, v85
    v_add_u32 v84, v84, v85
    v_add_u32 v84, 0x200, v84
    v_cmp_gt_u32 vcc, 8, v53
    s_nop 1
    v_cndmask_b32 v78, v84, v78, vcc
    v_lshlrev_b32 v84, 7, v53
    v_add_u32 v84, 0x400, v84
    v_mov_b32 v85, 0x800
    v_cndmask_b32 v82, v85, v84, vcc
    v_add_lshl_u32 v74, v74, v54, 1
    v_add_u32 v74, s5, v74
    v_add_lshl_u32 v78, v78, v54, 1
    v_add_u32 v78, s5, v78
    v_add_lshl_u32 v82, v82, v54, 1
    v_add_u32 v82, s5, v82
    v_lshl_add_u32 v53, v3, 2, 3
    v_and_b32 v75, 7, v53
    v_and_b32 v84, 8, v53
    v_lshlrev_b32 v84, 4, v84
    v_or_b32 v75, v75, v84
    v_and_b32 v84, 4, v53
    v_lshlrev_b32 v84, 5, v84
    v_and_b32 v85, 3, v53
    v_lshlrev_b32 v85, 1, v85
    v_add3_u32 v79, v84, v85, 0
    v_add_u32 v79, 0x100, v79
    v_and_b32 v84, 6, v53
    v_lshlrev_b32 v84, 6, v84
    v_and_b32 v85, 1, v53
    v_lshlrev_b32 v85, 2, v85
    v_add_u32 v84, v84, v85
    v_add_u32 v84, 0x200, v84
    v_cmp_gt_u32 vcc, 8, v53
    s_nop 1
    v_cndmask_b32 v79, v84, v79, vcc
    v_lshlrev_b32 v84, 7, v53
    v_add_u32 v84, 0x400, v84
    v_mov_b32 v85, 0x800
    v_cndmask_b32 v83, v85, v84, vcc
    v_add_lshl_u32 v75, v75, v54, 1
    v_add_u32 v75, s5, v75
    v_add_lshl_u32 v79, v79, v54, 1
    v_add_u32 v79, s5, v79
    v_add_lshl_u32 v83, v83, v54, 1
    v_add_u32 v83, s5, v83
    s_waitcnt lgkmcnt(0)
    v_add_f32 v40, v40, v56
    v_cvt_pk_bf16_f32 v40, v40, v40
    ds_write_b16 v72, v40
    v_add_f32 v41, v41, v57
    v_cvt_pk_bf16_f32 v41, v41, v41
    ds_write_b16 v73, v41
    v_add_f32 v42, v42, v58
    v_cvt_pk_bf16_f32 v42, v42, v42
    ds_write_b16 v74, v42
    v_add_f32 v43, v43, v59
    v_cvt_pk_bf16_f32 v43, v43, v43
    ds_write_b16 v75, v43
    v_add_f32 v44, v44, v60
    v_cvt_pk_bf16_f32 v44, v44, v44
    ds_write_b16 v76, v44
    v_add_f32 v45, v45, v61
    v_cvt_pk_bf16_f32 v45, v45, v45
    ds_write_b16 v77, v45
    v_add_f32 v46, v46, v62
    v_cvt_pk_bf16_f32 v46, v46, v46
    ds_write_b16 v78, v46
    v_add_f32 v47, v47, v63
    v_cvt_pk_bf16_f32 v47, v47, v47
    ds_write_b16 v79, v47
    v_add_f32 v48, v48, v64
    v_cvt_pk_bf16_f32 v48, v48, v48
    ds_write_b16 v80, v48
    v_add_f32 v49, v49, v65
    v_cvt_pk_bf16_f32 v49, v49, v49
    ds_write_b16 v81, v49
    v_add_f32 v50, v50, v66
    v_cvt_pk_bf16_f32 v50, v50, v50
    ds_write_b16 v82, v50
    v_add_f32 v51, v51, v67
    v_cvt_pk_bf16_f32 v51, v51, v51
    ds_write_b16 v83, v51
L_kgen_h1b:
    s_waitcnt lgkmcnt(0)
    s_barrier
    s_mul_i32 s24, s3, 4416
    s_add_u32 s24, s24, 7340032
    s_movk_i32 s25, 0x800
    v_mov_b32 v86, 4400
    v_and_b32 v6, 127, v0
    v_add_u32 v52, 0, v6
    v_lshlrev_b32 v53, 3, v52
    v_add_u32 v54, 0, v53
    v_sub_u32 v62, s25, v54
    v_cvt_f32_i32 v62, v62
    v_add_u32 v55, 1, v53
    v_sub_u32 v63, s25, v55
    v_cvt_f32_i32 v63, v63
    v_add_u32 v56, 2, v53
    v_sub_u32 v64, s25, v56
    v_cvt_f32_i32 v64, v64
    v_add_u32 v57, 3, v53
    v_sub_u32 v65, s25, v57
    v_cvt_f32_i32 v65, v65
    v_add_u32 v58, 4, v53
    v_sub_u32 v66, s25, v58
    v_cvt_f32_i32 v66, v66
    v_add_u32 v59, 5, v53
    v_sub_u32 v67, s25, v59
    v_cvt_f32_i32 v67, v67
    v_add_u32 v60, 6, v53
    v_sub_u32 v68, s25, v60
    v_cvt_f32_i32 v68, v68
    v_add_u32 v61, 7, v53
    v_sub_u32 v69, s25, v61
    v_cvt_f32_i32 v69, v69
    v_cvt_pk_bf16_f32 v70, v62, v63
    v_lshlrev_b32 v62, 16, v70
    v_and_b32 v63, s48, v70
    v_cvt_pk_bf16_f32 v70, v64, v65
    v_lshlrev_b32 v64, 16, v70
    v_and_b32 v65, s48, v70
    v_cvt_pk_bf16_f32 v70, v66, v67
    v_lshlrev_b32 v66, 16, v70
    v_and_b32 v67, s48, v70
    v_cvt_pk_bf16_f32 v70, v68, v69
    v_lshlrev_b32 v68, 16, v70
    v_and_b32 v69, s48, v70
    v_cvt_u32_f32 v62, v62
    v_lshlrev_b32 v62, 1, v62
    v_add_u32 v54, -1, v54
    v_cmp_gt_u32 vcc, s25, v54
    s_nop 1
    v_cndmask_b32 v62, v86, v62, vcc
    v_add_u32 v62, s5, v62
    v_cvt_u32_f32 v63, v63
    v_lshlrev_b32 v63, 1, v63
    v_add_u32 v55, -1, v55
    v_cmp_gt_u32 vcc, s25, v55
    s_nop 1
    v_cndmask_b32 v63, v86, v63, vcc
    v_add_u32 v63, s5, v63
    v_cvt_u32_f32 v64, v64
    v_lshlrev_b32 v64, 1, v64
    v_add_u32 v56, -1, v56
    v_cmp_gt_u32 vcc, s25, v56
    s_nop 1
    v_cndmask_b32 v64, v86, v64, vcc
    v_add_u32 v64, s5, v64
    v_cvt_u32_f32 v65, v65
    v_lshlrev_b32 v65, 1, v65
    v_add_u32 v57, -1, v57
    v_cmp_gt_u32 vcc, s25, v57
    s_nop 1
    v_cndmask_b32 v65, v86, v65, vcc
    v_add_u32 v65, s5, v65
    v_cvt_u32_f32 v66, v66
    v_lshlrev_b32 v66, 1, v66
    v_add_u32 v58, -1, v58
    v_cmp_gt_u32 vcc, s25, v58
    s_nop 1
    v_cndmask_b32 v66, v86, v66, vcc
    v_add_u32 v66, s5, v66
    v_cvt_u32_f32 v67, v67
    v_lshlrev_b32 v67, 1, v67
    v_add_u32 v59, -1, v59
    v_cmp_gt_u32 vcc, s25, v59
    s_nop 1
    v_cndmask_b32 v67, v86, v67, vcc
    v_add_u32 v67, s5, v67
    v_cvt_u32_f32 v68, v68
    v_lshlrev_b32 v68, 1, v68
    v_add_u32 v60, -1, v60
    v_cmp_gt_u32 vcc, s25, v60
    s_nop 1
    v_cndmask_b32 v68, v86, v68, vcc
    v_add_u32 v68, s5, v68
    v_cvt_u32_f32 v69, v69
    v_lshlrev_b32 v69, 1, v69
    v_add_u32 v61, -1, v61
    v_cmp_gt_u32 vcc, s25, v61
    s_nop 1
    v_cndmask_b32 v69, v86, v69, vcc
    v_add_u32 v69, s5, v69
    ds_read_u16 v54, v62
    ds_read_u16 v55, v63
    ds_read_u16 v56, v64
    ds_read_u16 v57, v65
    ds_read_u16 v58, v66
    ds_read_u16 v59, v67
    ds_read_u16 v60, v68
    ds_read_u16 v61, v69
    v_lshlrev_b32 v53, 4, v52
    s_waitcnt lgkmcnt(0)
    v_lshl_or_b32 v72, v55, 16, v54
    v_lshl_or_b32 v73, v57, 16, v56
    v_lshl_or_b32 v74, v59, 16, v58
    v_lshl_or_b32 v75, v61, 16, v60
    buffer_store_dwordx4 v[72:75], v53, s[40:43], s24 offen
    v_add_u32 v52, 128, v6
    v_lshlrev_b32 v53, 3, v52
    v_add_u32 v54, 0, v53
    v_sub_u32 v62, s25, v54
    v_cvt_f32_i32 v62, v62
    v_add_u32 v55, 1, v53
    v_sub_u32 v63, s25, v55
    v_cvt_f32_i32 v63, v63
    v_add_u32 v56, 2, v53
    v_sub_u32 v64, s25, v56
    v_cvt_f32_i32 v64, v64
    v_add_u32 v57, 3, v53
    v_sub_u32 v65, s25, v57
    v_cvt_f32_i32 v65, v65
    v_add_u32 v58, 4, v53
    v_sub_u32 v66, s25, v58
    v_cvt_f32_i32 v66, v66
    v_add_u32 v59, 5, v53
    v_sub_u32 v67, s25, v59
    v_cvt_f32_i32 v67, v67
    v_add_u32 v60, 6, v53
    v_sub_u32 v68, s25, v60
    v_cvt_f32_i32 v68, v68
    v_add_u32 v61, 7, v53
    v_sub_u32 v69, s25, v61
    v_cvt_f32_i32 v69, v69
    v_cvt_pk_bf16_f32 v70, v62, v63
    v_lshlrev_b32 v62, 16, v70
    v_and_b32 v63, s48, v70
    v_cvt_pk_bf16_f32 v70, v64, v65
    v_lshlrev_b32 v64, 16, v70
    v_and_b32 v65, s48, v70
    v_cvt_pk_bf16_f32 v70, v66, v67
    v_lshlrev_b32 v66, 16, v70
    v_and_b32 v67, s48, v70
    v_cvt_pk_bf16_f32 v70, v68, v69
    v_lshlrev_b32 v68, 16, v70
    v_and_b32 v69, s48, v70
    v_cvt_u32_f32 v62, v62
    v_lshlrev_b32 v62, 1, v62
    v_add_u32 v54, -1, v54
    v_cmp_gt_u32 vcc, s25, v54
    s_nop 1
    v_cndmask_b32 v62, v86, v62, vcc
    v_add_u32 v62, s5, v62
    v_cvt_u32_f32 v63, v63
    v_lshlrev_b32 v63, 1, v63
    v_add_u32 v55, -1, v55
    v_cmp_gt_u32 vcc, s25, v55
    s_nop 1
    v_cndmask_b32 v63, v86, v63, vcc
    v_add_u32 v63, s5, v63
    v_cvt_u32_f32 v64, v64
    v_lshlrev_b32 v64, 1, v64
    v_add_u32 v56, -1, v56
    v_cmp_gt_u32 vcc, s25, v56
    s_nop 1
    v_cndmask_b32 v64, v86, v64, vcc
    v_add_u32 v64, s5, v64
    v_cvt_u32_f32 v65, v65
    v_lshlrev_b32 v65, 1, v65
    v_add_u32 v57, -1, v57
    v_cmp_gt_u32 vcc, s25, v57
    s_nop 1
    v_cndmask_b32 v65, v86, v65, vcc
    v_add_u32 v65, s5, v65
    v_cvt_u32_f32 v66, v66
    v_lshlrev_b32 v66, 1, v66
    v_add_u32 v58, -1, v58
    v_cmp_gt_u32 vcc, s25, v58
    s_nop 1
    v_cndmask_b32 v66, v86, v66, vcc
    v_add_u32 v66, s5, v66
    v_cvt_u32_f32 v67, v67
    v_lshlrev_b32 v67, 1, v67
    v_add_u32 v59, -1, v59
    v_cmp_gt_u32 vcc, s25, v59
    s_nop 1
    v_cndmask_b32 v67, v86, v67, vcc
    v_add_u32 v67, s5, v67
    v_cvt_u32_f32 v68, v68
    v_lshlrev_b32 v68, 1, v68
    v_add_u32 v60, -1, v60
    v_cmp_gt_u32 vcc, s25, v60
    s_nop 1
    v_cndmask_b32 v68, v86, v68, vcc
    v_add_u32 v68, s5, v68
    v_cvt_u32_f32 v69, v69
    v_lshlrev_b32 v69, 1, v69
    v_add_u32 v61, -1, v61
    v_cmp_gt_u32 vcc, s25, v61
    s_nop 1
    v_cndmask_b32 v69, v86, v69, vcc
    v_add_u32 v69, s5, v69
    ds_read_u16 v54, v62
    ds_read_u16 v55, v63
    ds_read_u16 v56, v64
    ds_read_u16 v57, v65
    ds_read_u16 v58, v66
    ds_read_u16 v59, v67
    ds_read_u16 v60, v68
    ds_read_u16 v61, v69
    v_lshlrev_b32 v53, 4, v52
    s_waitcnt lgkmcnt(0)
    v_lshl_or_b32 v76, v55, 16, v54
    v_lshl_or_b32 v77, v57, 16, v56
    v_lshl_or_b32 v78, v59, 16, v58
    v_lshl_or_b32 v79, v61, 16, v60
    buffer_store_dwordx4 v[76:79], v53, s[40:43], s24 offen
    v_cmp_gt_u32 vcc, 20, v6
    s_nop 0
    s_and_saveexec_b64 s[28:29], vcc
    s_cbranch_execz L_kgen_exit
    v_add_u32 v52, 256, v6
    v_lshlrev_b32 v53, 3, v52
    v_add_u32 v54, 0, v53
    v_sub_u32 v62, s25, v54
    v_cvt_f32_i32 v62, v62
    v_add_u32 v55, 1, v53
    v_sub_u32 v63, s25, v55
    v_cvt_f32_i32 v63, v63
    v_add_u32 v56, 2, v53
    v_sub_u32 v64, s25, v56
    v_cvt_f32_i32 v64, v64
    v_add_u32 v57, 3, v53
    v_sub_u32 v65, s25, v57
    v_cvt_f32_i32 v65, v65
    v_add_u32 v58, 4, v53
    v_sub_u32 v66, s25, v58
    v_cvt_f32_i32 v66, v66
    v_add_u32 v59, 5, v53
    v_sub_u32 v67, s25, v59
    v_cvt_f32_i32 v67, v67
    v_add_u32 v60, 6, v53
    v_sub_u32 v68, s25, v60
    v_cvt_f32_i32 v68, v68
    v_add_u32 v61, 7, v53
    v_sub_u32 v69, s25, v61
    v_cvt_f32_i32 v69, v69
    v_cvt_pk_bf16_f32 v70, v62, v63
    v_lshlrev_b32 v62, 16, v70
    v_and_b32 v63, s48, v70
    v_cvt_pk_bf16_f32 v70, v64, v65
    v_lshlrev_b32 v64, 16, v70
    v_and_b32 v65, s48, v70
    v_cvt_pk_bf16_f32 v70, v66, v67
    v_lshlrev_b32 v66, 16, v70
    v_and_b32 v67, s48, v70
    v_cvt_pk_bf16_f32 v70, v68, v69
    v_lshlrev_b32 v68, 16, v70
    v_and_b32 v69, s48, v70
    v_cvt_u32_f32 v62, v62
    v_lshlrev_b32 v62, 1, v62
    v_add_u32 v54, -1, v54
    v_cmp_gt_u32 vcc, s25, v54
    s_nop 1
    v_cndmask_b32 v62, v86, v62, vcc
    v_add_u32 v62, s5, v62
    v_cvt_u32_f32 v63, v63
    v_lshlrev_b32 v63, 1, v63
    v_add_u32 v55, -1, v55
    v_cmp_gt_u32 vcc, s25, v55
    s_nop 1
    v_cndmask_b32 v63, v86, v63, vcc
    v_add_u32 v63, s5, v63
    v_cvt_u32_f32 v64, v64
    v_lshlrev_b32 v64, 1, v64
    v_add_u32 v56, -1, v56
    v_cmp_gt_u32 vcc, s25, v56
    s_nop 1
    v_cndmask_b32 v64, v86, v64, vcc
    v_add_u32 v64, s5, v64
    v_cvt_u32_f32 v65, v65
    v_lshlrev_b32 v65, 1, v65
    v_add_u32 v57, -1, v57
    v_cmp_gt_u32 vcc, s25, v57
    s_nop 1
    v_cndmask_b32 v65, v86, v65, vcc
    v_add_u32 v65, s5, v65
    v_cvt_u32_f32 v66, v66
    v_lshlrev_b32 v66, 1, v66
    v_add_u32 v58, -1, v58
    v_cmp_gt_u32 vcc, s25, v58
    s_nop 1
    v_cndmask_b32 v66, v86, v66, vcc
    v_add_u32 v66, s5, v66
    v_cvt_u32_f32 v67, v67
    v_lshlrev_b32 v67, 1, v67
    v_add_u32 v59, -1, v59
    v_cmp_gt_u32 vcc, s25, v59
    s_nop 1
    v_cndmask_b32 v67, v86, v67, vcc
    v_add_u32 v67, s5, v67
    v_cvt_u32_f32 v68, v68
    v_lshlrev_b32 v68, 1, v68
    v_add_u32 v60, -1, v60
    v_cmp_gt_u32 vcc, s25, v60
    s_nop 1
    v_cndmask_b32 v68, v86, v68, vcc
    v_add_u32 v68, s5, v68
    v_cvt_u32_f32 v69, v69
    v_lshlrev_b32 v69, 1, v69
    v_add_u32 v61, -1, v61
    v_cmp_gt_u32 vcc, s25, v61
    s_nop 1
    v_cndmask_b32 v69, v86, v69, vcc
    v_add_u32 v69, s5, v69
    ds_read_u16 v54, v62
    ds_read_u16 v55, v63
    ds_read_u16 v56, v64
    ds_read_u16 v57, v65
    ds_read_u16 v58, v66
    ds_read_u16 v59, v67
    ds_read_u16 v60, v68
    ds_read_u16 v61, v69
    v_lshlrev_b32 v53, 4, v52
    s_waitcnt lgkmcnt(0)
    v_lshl_or_b32 v72, v55, 16, v54
    v_lshl_or_b32 v73, v57, 16, v56
    v_lshl_or_b32 v74, v59, 16, v58
    v_lshl_or_b32 v75, v61, 16, v60
    buffer_store_dwordx4 v[72:75], v53, s[40:43], s24 offen
L_kgen_exit:
    s_endpgm
L_k1_b:
    s_sub_u32 s2, s2, 256
    s_load_dwordx4 s[8:11], s[0:1], 0
    s_load_dwordx2 s[12:13], s[0:1], 96
    s_and_b32 s5, s2, 1
    s_lshl_b32 s5, s5, 4
    s_lshr_b32 s46, s2, 4
    s_add_u32 s5, s5, s46
    s_and_b32 s6, s2, 6
    s_bfe_u32 s47, s2, 0x10003
    s_add_u32 s6, s6, s47
    v_and_b32 v1, 63, v0
    v_lshrrev_b32 v4, 6, v0
    s_nop 0
    v_readfirstlane_b32 s4, v4
    s_nop 0
    s_cmp_lt_u32 s4, 4
    s_cbranch_scc1 L_a1_cons
    v_and_b32 v4, 3, v4
    s_and_b32 s4, s4, 3
    s_mul_i32 s7, s6, 160
    v_lshl_add_u32 v16, v4, 6, v1
    v_add_u32 v16, 0, v16
    v_min_u32 v16, 959, v16
    v_mul_u32_u24 v17, 2185, v16
    v_lshrrev_b32 v17, 16, v17
    v_mul_u32_u24 v18, 30, v17
    v_sub_u32 v18, v16, v18
    v_mul_u32_u24 v19, 6554, v18
    v_lshrrev_b32 v19, 16, v19
    v_mul_u32_u24 v20, 10, v19
    v_sub_u32 v18, v18, v20
    v_mul_u32_u24 v17, 3840, v17
    v_mul_u32_u24 v19, 1280, v19
    v_lshl_add_u32 v17, v18, 4, v17
    v_add3_u32 v8, v17, v19, s7
    v_lshl_add_u32 v16, v4, 6, v1
    v_add_u32 v16, 256, v16
    v_min_u32 v16, 959, v16
    v_mul_u32_u24 v17, 2185, v16
    v_lshrrev_b32 v17, 16, v17
    v_mul_u32_u24 v18, 30, v17
    v_sub_u32 v18, v16, v18
    v_mul_u32_u24 v19, 6554, v18
    v_lshrrev_b32 v19, 16, v19
    v_mul_u32_u24 v20, 10, v19
    v_sub_u32 v18, v18, v20
    v_mul_u32_u24 v17, 3840, v17
    v_mul_u32_u24 v19, 1280, v19
    v_lshl_add_u32 v17, v18, 4, v17
    v_add3_u32 v9, v17, v19, s7
    v_lshl_add_u32 v16, v4, 6, v1
    v_add_u32 v16, 512, v16
    v_min_u32 v16, 959, v16
    v_mul_u32_u24 v17, 2185, v16
    v_lshrrev_b32 v17, 16, v17
    v_mul_u32_u24 v18, 30, v17
    v_sub_u32 v18, v16, v18
    v_mul_u32_u24 v19, 6554, v18
    v_lshrrev_b32 v19, 16, v19
    v_mul_u32_u24 v20, 10, v19
    v_sub_u32 v18, v18, v20
    v_mul_u32_u24 v17, 3840, v17
    v_mul_u32_u24 v19, 1280, v19
    v_lshl_add_u32 v17, v18, 4, v17
    v_add3_u32 v10, v17, v19, s7
    v_lshl_add_u32 v16, v4, 6, v1
    v_add_u32 v16, 768, v16
    v_min_u32 v16, 959, v16
    v_mul_u32_u24 v17, 2185, v16
    v_lshrrev_b32 v17, 16, v17
    v_mul_u32_u24 v18, 30, v17
    v_sub_u32 v18, v16, v18
    v_mul_u32_u24 v19, 6554, v18
    v_lshrrev_b32 v19, 16, v19
    v_mul_u32_u24 v20, 10, v19
    v_sub_u32 v18, v18, v20
    v_mul_u32_u24 v17, 3840, v17
    v_mul_u32_u24 v19, 1280, v19
    v_lshl_add_u32 v17, v18, 4, v17
    v_add3_u32 v11, v17, v19, s7
    v_lshrrev_b32 v16, 2, v1
    v_and_b32 v17, 3, v1
    v_bfe_u32 v18, v1, 4, 2
    v_xor_b32 v17, v17, v18
    s_lshl_b32 s7, s5, 6
    v_lshl_add_u32 v16, v4, 4, v16
    v_add_u32 v16, s7, v16
    v_mul_u32_u24 v12, 1280, v16
    v_lshl_add_u32 v12, v17, 4, v12
    s_waitcnt lgkmcnt(0)
    s_mov_b32 s16, s8
    s_mov_b32 s17, s9
    s_mov_b32 s18, 2621440
    s_mov_b32 s19, 0x00020000
    s_mov_b32 s20, s10
    s_mov_b32 s21, s11
    s_mov_b32 s22, 2457600
    s_mov_b32 s23, 0x00020000
    s_lshl_b32 s28, s4, 10
    s_mov_b32 s29, 0
    s_mov_b32 s30, 0
    v_lshrrev_b32 v23, 3, v1
    v_lshl_add_u32 v23, v4, 3, v23
    s_lshl_b32 s32, s5, 6
    s_lshl_b32 s33, s47, 5
    s_add_u32 s32, s32, s33
    v_add_u32 v23, s32, v23
    v_mul_u32_u24 v23, 1280, v23
    v_and_b32 v24, 7, v1
    v_lshl_add_u32 v23, v24, 4, v23
    v_min_u32 v24, 29, v1
    v_mul_u32_u24 v27, 6554, v24
    v_lshrrev_b32 v27, 16, v27
    v_mul_u32_u24 v28, 10, v27
    v_sub_u32 v26, v24, v28
    v_mul_u32_u24 v27, 1280, v27
    v_lshl_add_u32 v25, v26, 4, v27
    s_lshl_b32 s32, s46, 2
    s_add_u32 s32, s32, s4
    s_mul_i32 s32, s32, 3840
    s_mul_i32 s33, s6, 160
    s_add_u32 s32, s32, s33
    s_cmp_eq_u32 s4, 3
    s_cbranch_scc1 L_a1_prod3
    s_add_u32 m0, s28, 0
    s_nop 0
    buffer_load_dwordx4 v8, s[20:23], s29 offen lds
    s_add_u32 m0, s28, 4096
    s_nop 0
    buffer_load_dwordx4 v9, s[20:23], s29 offen lds
    s_add_u32 m0, s28, 8192
    s_nop 0
    buffer_load_dwordx4 v10, s[20:23], s29 offen lds
    s_add_u32 m0, s28, 12288
    s_nop 0
    buffer_load_dwordx4 v11, s[20:23], s29 offen lds
    s_add_u32 m0, s28, 15360
    s_nop 0
    buffer_load_dwordx4 v12, s[16:19], s30 offen lds
    s_add_u32 s29, s29, 122880
    s_add_u32 s30, s30, 64
    s_add_u32 m0, s28, 19456
    s_nop 0
    buffer_load_dwordx4 v8, s[20:23], s29 offen lds
    s_add_u32 m0, s28, 23552
    s_nop 0
    buffer_load_dwordx4 v9, s[20:23], s29 offen lds
    s_add_u32 m0, s28, 27648
    s_nop 0
    buffer_load_dwordx4 v10, s[20:23], s29 offen lds
    s_add_u32 m0, s28, 31744
    s_nop 0
    buffer_load_dwordx4 v11, s[20:23], s29 offen lds
    s_add_u32 m0, s28, 34816
    s_nop 0
    buffer_load_dwordx4 v12, s[16:19], s30 offen lds
    s_add_u32 s29, s29, 122880
    s_add_u32 s30, s30, 64
    s_add_u32 m0, s28, 38912
    s_nop 0
    buffer_load_dwordx4 v8, s[20:23], s29 offen lds
    s_add_u32 m0, s28, 43008
    s_nop 0
    buffer_load_dwordx4 v9, s[20:23], s29 offen lds
    s_add_u32 m0, s28, 47104
    s_nop 0
    buffer_load_dwordx4 v10, s[20:23], s29 offen lds
    s_add_u32 m0, s28, 51200
    s_nop 0
    buffer_load_dwordx4 v11, s[20:23], s29 offen lds
    s_add_u32 m0, s28, 54272
    s_nop 0
    buffer_load_dwordx4 v12, s[16:19], s30 offen lds
    s_add_u32 s29, s29, 122880
    s_add_u32 s30, s30, 64
    s_add_u32 s33, s32, 245760
    buffer_load_dwordx4 v[32:35], v25, s[20:23], s33 offen
    buffer_load_dwordx4 v[36:39], v23, s[16:19], 0 offen offset:128
    s_add_u32 s33, s32, 491520
    buffer_load_dwordx4 v[32:35], v25, s[20:23], s33 offen
    buffer_load_dwordx4 v[36:39], v23, s[16:19], 0 offen offset:256
    s_add_u32 s33, s32, 737280
    buffer_load_dwordx4 v[32:35], v25, s[20:23], s33 offen
    buffer_load_dwordx4 v[36:39], v23, s[16:19], 0 offen offset:384
    s_add_u32 s33, s32, 983040
    buffer_load_dwordx4 v[32:35], v25, s[20:23], s33 offen
    buffer_load_dwordx4 v[36:39], v23, s[16:19], 0 offen offset:512
    s_add_u32 s33, s32, 1228800
    buffer_load_dwordx4 v[32:35], v25, s[20:23], s33 offen
    buffer_load_dwordx4 v[36:39], v23, s[16:19], 0 offen offset:640
    s_add_u32 s33, s32, 1474560
    buffer_load_dwordx4 v[32:35], v25, s[20:23], s33 offen
    buffer_load_dwordx4 v[36:39], v23, s[16:19], 0 offen offset:768
    s_add_u32 s33, s32, 1720320
    buffer_load_dwordx4 v[32:35], v25, s[20:23], s33 offen
    buffer_load_dwordx4 v[36:39], v23, s[16:19], 0 offen offset:896
    s_add_u32 s33, s32, 1966080
    buffer_load_dwordx4 v[32:35], v25, s[20:23], s33 offen
    buffer_load_dwordx4 v[36:39], v23, s[16:19], 0 offen offset:1024
    s_add_u32 s33, s32, 2211840
    buffer_load_dwordx4 v[32:35], v25, s[20:23], s33 offen
    buffer_load_dwordx4 v[36:39], v23, s[16:19], 0 offen offset:1152
    s_waitcnt vmcnt(28)
    s_barrier
    s_add_u32 m0, s28, 58368
    s_nop 0
    buffer_load_dwordx4 v8, s[20:23], s29 offen lds
    s_add_u32 m0, s28, 62464
    s_nop 0
    buffer_load_dwordx4 v9, s[20:23], s29 offen lds
    s_add_u32 m0, s28, 66560
    s_nop 0
    buffer_load_dwordx4 v10, s[20:23], s29 offen lds
    s_add_u32 m0, s28, 70656
    s_nop 0
    buffer_load_dwordx4 v11, s[20:23], s29 offen lds
    s_add_u32 m0, s28, 73728
    s_nop 0
    buffer_load_dwordx4 v12, s[16:19], s30 offen lds
    s_add_u32 s29, s29, 122880
    s_add_u32 s30, s30, 64
    s_waitcnt vmcnt(28)
    s_barrier
    s_add_u32 m0, s28, 0
    s_nop 0
    buffer_load_dwordx4 v8, s[20:23], s29 offen lds
    s_add_u32 m0, s28, 4096
    s_nop 0
    buffer_load_dwordx4 v9, s[20:23], s29 offen lds
    s_add_u32 m0, s28, 8192
    s_nop 0
    buffer_load_dwordx4 v10, s[20:23], s29 offen lds
    s_add_u32 m0, s28, 12288
    s_nop 0
    buffer_load_dwordx4 v11, s[20:23], s29 offen lds
    s_add_u32 m0, s28, 15360
    s_nop 0
    buffer_load_dwordx4 v12, s[16:19], s30 offen lds
    s_add_u32 s29, s29, 122880
    s_add_u32 s30, s30, 64
    s_waitcnt vmcnt(28)
    s_barrier
    s_add_u32 m0, s28, 19456
    s_nop 0
    buffer_load_dwordx4 v8, s[20:23], s29 offen lds
    s_add_u32 m0, s28, 23552
    s_nop 0
    buffer_load_dwordx4 v9, s[20:23], s29 offen lds
    s_add_u32 m0, s28, 27648
    s_nop 0
    buffer_load_dwordx4 v10, s[20:23], s29 offen lds
    s_add_u32 m0, s28, 31744
    s_nop 0
    buffer_load_dwordx4 v11, s[20:23], s29 offen lds
    s_add_u32 m0, s28, 34816
    s_nop 0
    buffer_load_dwordx4 v12, s[16:19], s30 offen lds
    s_add_u32 s29, s29, 122880
    s_add_u32 s30, s30, 64
    s_mov_b32 s34, 38912
    s_mov_b32 s35, 3
L_a1_pl4:
    s_waitcnt vmcnt(10)
    s_barrier
    s_add_u32 s36, s28, s34
    s_add_u32 m0, s36, 0
    s_nop 0
    buffer_load_dwordx4 v8, s[20:23], s29 offen lds
    s_add_u32 m0, s36, 4096
    s_nop 0
    buffer_load_dwordx4 v9, s[20:23], s29 offen lds
    s_add_u32 m0, s36, 8192
    s_nop 0
    buffer_load_dwordx4 v10, s[20:23], s29 offen lds
    s_add_u32 m0, s36, 12288
    s_nop 0
    buffer_load_dwordx4 v11, s[20:23], s29 offen lds
    s_add_u32 m0, s36, 15360
    s_nop 0
    buffer_load_dwordx4 v12, s[16:19], s30 offen lds
    s_add_u32 s29, s29, 122880
    s_add_u32 s30, s30, 64
    s_add_u32 s34, s34, 19456
    s_cmp_ge_u32 s34, 77824
    s_cselect_b32 s34, 0, s34
    s_add_u32 s35, s35, 1
    s_cmp_lt_u32 s35, 17
    s_cbranch_scc1 L_a1_pl4
    s_waitcnt vmcnt(10)
    s_barrier
    s_waitcnt vmcnt(5)
    s_barrier
    s_waitcnt vmcnt(0)
    s_barrier
    s_endpgm
L_a1_prod3:
    s_add_u32 m0, s28, 0
    s_nop 0
    buffer_load_dwordx4 v8, s[20:23], s29 offen lds
    s_add_u32 m0, s28, 4096
    s_nop 0
    buffer_load_dwordx4 v9, s[20:23], s29 offen lds
    s_add_u32 m0, s28, 8192
    s_nop 0
    buffer_load_dwordx4 v10, s[20:23], s29 offen lds
    s_add_u32 m0, s28, 15360
    s_nop 0
    buffer_load_dwordx4 v12, s[16:19], s30 offen lds
    s_add_u32 s29, s29, 122880
    s_add_u32 s30, s30, 64
    s_add_u32 m0, s28, 19456
    s_nop 0
    buffer_load_dwordx4 v8, s[20:23], s29 offen lds
    s_add_u32 m0, s28, 23552
    s_nop 0
    buffer_load_dwordx4 v9, s[20:23], s29 offen lds
    s_add_u32 m0, s28, 27648
    s_nop 0
    buffer_load_dwordx4 v10, s[20:23], s29 offen lds
    s_add_u32 m0, s28, 34816
    s_nop 0
    buffer_load_dwordx4 v12, s[16:19], s30 offen lds
    s_add_u32 s29, s29, 122880
    s_add_u32 s30, s30, 64
    s_add_u32 m0, s28, 38912
    s_nop 0
    buffer_load_dwordx4 v8, s[20:23], s29 offen lds
    s_add_u32 m0, s28, 43008
    s_nop 0
    buffer_load_dwordx4 v9, s[20:23], s29 offen lds
    s_add_u32 m0, s28, 47104
    s_nop 0
    buffer_load_dwordx4 v10, s[20:23], s29 offen lds
    s_add_u32 m0, s28, 54272
    s_nop 0
    buffer_load_dwordx4 v12, s[16:19], s30 offen lds
    s_add_u32 s29, s29, 122880
    s_add_u32 s30, s30, 64
    s_add_u32 s33, s32, 245760
    buffer_load_dwordx4 v[32:35], v25, s[20:23], s33 offen
    buffer_load_dwordx4 v[36:39], v23, s[16:19], 0 offen offset:128
    s_add_u32 s33, s32, 491520
    buffer_load_dwordx4 v[32:35], v25, s[20:23], s33 offen
    buffer_load_dwordx4 v[36:39], v23, s[16:19], 0 offen offset:256
    s_add_u32 s33, s32, 737280
    buffer_load_dwordx4 v[32:35], v25, s[20:23], s33 offen
    buffer_load_dwordx4 v[36:39], v23, s[16:19], 0 offen offset:384
    s_add_u32 s33, s32, 983040
    buffer_load_dwordx4 v[32:35], v25, s[20:23], s33 offen
    buffer_load_dwordx4 v[36:39], v23, s[16:19], 0 offen offset:512
    s_add_u32 s33, s32, 1228800
    buffer_load_dwordx4 v[32:35], v25, s[20:23], s33 offen
    buffer_load_dwordx4 v[36:39], v23, s[16:19], 0 offen offset:640
    s_add_u32 s33, s32, 1474560
    buffer_load_dwordx4 v[32:35], v25, s[20:23], s33 offen
    buffer_load_dwordx4 v[36:39], v23, s[16:19], 0 offen offset:768
    s_add_u32 s33, s32, 1720320
    buffer_load_dwordx4 v[32:35], v25, s[20:23], s33 offen
    buffer_load_dwordx4 v[36:39], v23, s[16:19], 0 offen offset:896
    s_add_u32 s33, s32, 1966080
    buffer_load_dwordx4 v[32:35], v25, s[20:23], s33 offen
    buffer_load_dwordx4 v[36:39], v23, s[16:19], 0 offen offset:1024
    s_add_u32 s33, s32, 2211840
    buffer_load_dwordx4 v[32:35], v25, s[20:23], s33 offen
    buffer_load_dwordx4 v[36:39], v23, s[16:19], 0 offen offset:1152
    s_waitcnt vmcnt(26)
    s_barrier
    s_add_u32 m0, s28, 58368
    s_nop 0
    buffer_load_dwordx4 v8, s[20:23], s29 offen lds
    s_add_u32 m0, s28, 62464
    s_nop 0
    buffer_load_dwordx4 v9, s[20:23], s29 offen lds
    s_add_u32 m0, s28, 66560
    s_nop 0
    buffer_load_dwordx4 v10, s[20:23], s29 offen lds
    s_add_u32 m0, s28, 73728
    s_nop 0
    buffer_load_dwordx4 v12, s[16:19], s30 offen lds
    s_add_u32 s29, s29, 122880
    s_add_u32 s30, s30, 64
    s_waitcnt vmcnt(26)
    s_barrier
    s_add_u32 m0, s28, 0
    s_nop 0
    buffer_load_dwordx4 v8, s[20:23], s29 offen lds
    s_add_u32 m0, s28, 4096
    s_nop 0
    buffer_load_dwordx4 v9, s[20:23], s29 offen lds
    s_add_u32 m0, s28, 8192
    s_nop 0
    buffer_load_dwordx4 v10, s[20:23], s29 offen lds
    s_add_u32 m0, s28, 15360
    s_nop 0
    buffer_load_dwordx4 v12, s[16:19], s30 offen lds
    s_add_u32 s29, s29, 122880
    s_add_u32 s30, s30, 64
    s_waitcnt vmcnt(26)
    s_barrier
    s_add_u32 m0, s28, 19456
    s_nop 0
    buffer_load_dwordx4 v8, s[20:23], s29 offen lds
    s_add_u32 m0, s28, 23552
    s_nop 0
    buffer_load_dwordx4 v9, s[20:23], s29 offen lds
    s_add_u32 m0, s28, 27648
    s_nop 0
    buffer_load_dwordx4 v10, s[20:23], s29 offen lds
    s_add_u32 m0, s28, 34816
    s_nop 0
    buffer_load_dwordx4 v12, s[16:19], s30 offen lds
    s_add_u32 s29, s29, 122880
    s_add_u32 s30, s30, 64
    s_mov_b32 s34, 38912
    s_mov_b32 s35, 3
L_a1_pl3:
    s_waitcnt vmcnt(8)
    s_barrier
    s_add_u32 s36, s28, s34
    s_add_u32 m0, s36, 0
    s_nop 0
    buffer_load_dwordx4 v8, s[20:23], s29 offen lds
    s_add_u32 m0, s36, 4096
    s_nop 0
    buffer_load_dwordx4 v9, s[20:23], s29 offen lds
    s_add_u32 m0, s36, 8192
    s_nop 0
    buffer_load_dwordx4 v10, s[20:23], s29 offen lds
    s_add_u32 m0, s36, 15360
    s_nop 0
    buffer_load_dwordx4 v12, s[16:19], s30 offen lds
    s_add_u32 s29, s29, 122880
    s_add_u32 s30, s30, 64
    s_add_u32 s34, s34, 19456
    s_cmp_ge_u32 s34, 77824
    s_cselect_b32 s34, 0, s34
    s_add_u32 s35, s35, 1
    s_cmp_lt_u32 s35, 17
    s_cbranch_scc1 L_a1_pl3
    s_waitcnt vmcnt(8)
    s_barrier
    s_waitcnt vmcnt(4)
    s_barrier
    s_waitcnt vmcnt(0)
    s_barrier
    s_endpgm
L_a1_cons:
    v_lshrrev_b32 v16, 4, v1
    v_bfe_u32 v17, v1, 2, 2
    v_and_b32 v18, 3, v1
    v_lshl_add_u32 v13, v16, 2, v17
    v_mul_u32_u24 v13, 480, v13
    v_lshl_add_u32 v13, v18, 3, v13
    v_lshl_add_u32 v13, v4, 5, v13
    v_and_b32 v19, 15, v1
    v_lshrrev_b32 v20, 1, v16
    v_lshrrev_b32 v21, 2, v19
    v_xor_b32 v20, v20, v21
    v_xor_b32 v21, 2, v20
    v_and_b32 v22, 1, v16
    v_lshlrev_b32 v22, 3, v22
    v_lshl_add_u32 v22, v19, 6, v22
    v_add_u32 v22, 15360, v22
    v_lshl_add_u32 v14, v20, 4, v22
    v_lshl_add_u32 v15, v21, 4, v22
    v_add_u32 v2, 38912, v13
    v_add_u32 v3, 38912, v14
    v_add_u32 v5, 38912, v15
    s_waitcnt lgkmcnt(0)
    s_mov_b32 s24, s12
    s_mov_b32 s25, s13
    s_mov_b32 s26, 16777216
    s_mov_b32 s27, 0x00020000
    s_mov_b32 s16, s8
    s_mov_b32 s17, s9
    s_mov_b32 s18, 2621440
    s_mov_b32 s19, 0x00020000
    s_mov_b32 s20, s10
    s_mov_b32 s21, s11
    s_mov_b32 s22, 2457600
    s_mov_b32 s23, 0x00020000
    v_mov_b32 v52, 0
    v_mov_b32 v53, 0
    v_mov_b32 v54, 0
    v_mov_b32 v55, 0
    v_mov_b32 v56, 0
    v_mov_b32 v57, 0
    v_mov_b32 v58, 0
    v_mov_b32 v59, 0
    v_mov_b32 v60, 0
    v_mov_b32 v61, 0
    v_mov_b32 v62, 0
    v_mov_b32 v63, 0
    v_mov_b32 v64, 0
    v_mov_b32 v65, 0
    v_mov_b32 v66, 0
    v_mov_b32 v67, 0
    v_mov_b32 v68, 0
    v_mov_b32 v69, 0
    v_mov_b32 v70, 0
    v_mov_b32 v71, 0
    v_mov_b32 v72, 0
    v_mov_b32 v73, 0
    v_mov_b32 v74, 0
    v_mov_b32 v75, 0
    v_mov_b32 v76, 0
    v_mov_b32 v77, 0
    v_mov_b32 v78, 0
    v_mov_b32 v79, 0
    v_mov_b32 v80, 0
    v_mov_b32 v81, 0
    v_mov_b32 v82, 0
    v_mov_b32 v83, 0
    v_mov_b32 v84, 0
    v_mov_b32 v85, 0
    v_mov_b32 v86, 0
    v_mov_b32 v87, 0
    v_mov_b32 v88, 0
    v_mov_b32 v89, 0
    v_mov_b32 v90, 0
    v_mov_b32 v91, 0
    v_mov_b32 v92, 0
    v_mov_b32 v93, 0
    v_mov_b32 v94, 0
    v_mov_b32 v95, 0
    v_mov_b32 v96, 0
    v_mov_b32 v97, 0
    v_mov_b32 v98, 0
    v_mov_b32 v99, 0
    v_mov_b32 v100, 0
    v_mov_b32 v101, 0
    v_mov_b32 v102, 0
    v_mov_b32 v103, 0
    v_mov_b32 v104, 0
    v_mov_b32 v105, 0
    v_mov_b32 v106, 0
    v_mov_b32 v107, 0
    v_mov_b32 v108, 0
    v_mov_b32 v109, 0
    v_mov_b32 v110, 0
    v_mov_b32 v111, 0
    v_mov_b32 v112, 0
    v_mov_b32 v113, 0
    v_mov_b32 v114, 0
    v_mov_b32 v115, 0
    s_mov_b32 s31, 0
L_a1_loop:
    s_barrier
    ds_read_b64_tr_b16 v[20:21], v13 offset:0
    ds_read_b64_tr_b16 v[22:23], v13 offset:7680
    ds_read_b64 v[36:37], v14 offset:0
    ds_read_b64 v[38:39], v15 offset:0
    ds_read_b64_tr_b16 v[24:25], v13 offset:128
    ds_read_b64_tr_b16 v[26:27], v13 offset:7808
    ds_read_b64 v[40:41], v14 offset:1024
    ds_read_b64 v[42:43], v15 offset:1024
    ds_read_b64_tr_b16 v[28:29], v13 offset:256
    ds_read_b64_tr_b16 v[30:31], v13 offset:7936
    ds_read_b64 v[44:45], v14 offset:2048
    ds_read_b64 v[46:47], v15 offset:2048
    ds_read_b64_tr_b16 v[32:33], v13 offset:384
    ds_read_b64_tr_b16 v[34:35], v13 offset:8064
    ds_read_b64 v[48:49], v14 offset:3072
    ds_read_b64 v[50:51], v15 offset:3072
    s_waitcnt lgkmcnt(12)
    v_mfma_f32_16x16x32_bf16 v[52:55], v[20:23], v[36:39], v[52:55]
    s_waitcnt lgkmcnt(8)
    v_mfma_f32_16x16x32_bf16 v[68:71], v[24:27], v[36:39], v[68:71]
    v_mfma_f32_16x16x32_bf16 v[72:75], v[24:27], v[40:43], v[72:75]
    v_mfma_f32_16x16x32_bf16 v[56:59], v[20:23], v[40:43], v[56:59]
    s_waitcnt lgkmcnt(4)
    v_mfma_f32_16x16x32_bf16 v[84:87], v[28:31], v[36:39], v[84:87]
    v_mfma_f32_16x16x32_bf16 v[88:91], v[28:31], v[40:43], v[88:91]
    v_mfma_f32_16x16x32_bf16 v[92:95], v[28:31], v[44:47], v[92:95]
    v_mfma_f32_16x16x32_bf16 v[60:63], v[20:23], v[44:47], v[60:63]
    v_mfma_f32_16x16x32_bf16 v[76:79], v[24:27], v[44:47], v[76:79]
    s_waitcnt lgkmcnt(0)
    v_mfma_f32_16x16x32_bf16 v[100:103], v[32:35], v[36:39], v[100:103]
    v_mfma_f32_16x16x32_bf16 v[104:107], v[32:35], v[40:43], v[104:107]
    v_mfma_f32_16x16x32_bf16 v[108:111], v[32:35], v[44:47], v[108:111]
    v_mfma_f32_16x16x32_bf16 v[112:115], v[32:35], v[48:51], v[112:115]
    v_mfma_f32_16x16x32_bf16 v[64:67], v[20:23], v[48:51], v[64:67]
    v_mfma_f32_16x16x32_bf16 v[80:83], v[24:27], v[48:51], v[80:83]
    v_mfma_f32_16x16x32_bf16 v[96:99], v[28:31], v[48:51], v[96:99]
    s_barrier
    ds_read_b64_tr_b16 v[20:21], v13 offset:19456
    ds_read_b64_tr_b16 v[22:23], v13 offset:27136
    ds_read_b64 v[36:37], v14 offset:19456
    ds_read_b64 v[38:39], v15 offset:19456
    ds_read_b64_tr_b16 v[24:25], v13 offset:19584
    ds_read_b64_tr_b16 v[26:27], v13 offset:27264
    ds_read_b64 v[40:41], v14 offset:20480
    ds_read_b64 v[42:43], v15 offset:20480
    ds_read_b64_tr_b16 v[28:29], v13 offset:19712
    ds_read_b64_tr_b16 v[30:31], v13 offset:27392
    ds_read_b64 v[44:45], v14 offset:21504
    ds_read_b64 v[46:47], v15 offset:21504
    ds_read_b64_tr_b16 v[32:33], v13 offset:19840
    ds_read_b64_tr_b16 v[34:35], v13 offset:27520
    ds_read_b64 v[48:49], v14 offset:22528
    ds_read_b64 v[50:51], v15 offset:22528
    s_waitcnt lgkmcnt(12)
    v_mfma_f32_16x16x32_bf16 v[52:55], v[20:23], v[36:39], v[52:55]
    s_waitcnt lgkmcnt(8)
    v_mfma_f32_16x16x32_bf16 v[68:71], v[24:27], v[36:39], v[68:71]
    v_mfma_f32_16x16x32_bf16 v[72:75], v[24:27], v[40:43], v[72:75]
    v_mfma_f32_16x16x32_bf16 v[56:59], v[20:23], v[40:43], v[56:59]
    s_waitcnt lgkmcnt(4)
    v_mfma_f32_16x16x32_bf16 v[84:87], v[28:31], v[36:39], v[84:87]
    v_mfma_f32_16x16x32_bf16 v[88:91], v[28:31], v[40:43], v[88:91]
    v_mfma_f32_16x16x32_bf16 v[92:95], v[28:31], v[44:47], v[92:95]
    v_mfma_f32_16x16x32_bf16 v[60:63], v[20:23], v[44:47], v[60:63]
    v_mfma_f32_16x16x32_bf16 v[76:79], v[24:27], v[44:47], v[76:79]
    s_waitcnt lgkmcnt(0)
    v_mfma_f32_16x16x32_bf16 v[100:103], v[32:35], v[36:39], v[100:103]
    v_mfma_f32_16x16x32_bf16 v[104:107], v[32:35], v[40:43], v[104:107]
    v_mfma_f32_16x16x32_bf16 v[108:111], v[32:35], v[44:47], v[108:111]
    v_mfma_f32_16x16x32_bf16 v[112:115], v[32:35], v[48:51], v[112:115]
    v_mfma_f32_16x16x32_bf16 v[64:67], v[20:23], v[48:51], v[64:67]
    v_mfma_f32_16x16x32_bf16 v[80:83], v[24:27], v[48:51], v[80:83]
    v_mfma_f32_16x16x32_bf16 v[96:99], v[28:31], v[48:51], v[96:99]
    s_barrier
    ds_read_b64_tr_b16 v[20:21], v2 offset:0
    ds_read_b64_tr_b16 v[22:23], v2 offset:7680
    ds_read_b64 v[36:37], v3 offset:0
    ds_read_b64 v[38:39], v5 offset:0
    ds_read_b64_tr_b16 v[24:25], v2 offset:128
    ds_read_b64_tr_b16 v[26:27], v2 offset:7808
    ds_read_b64 v[40:41], v3 offset:1024
    ds_read_b64 v[42:43], v5 offset:1024
    ds_read_b64_tr_b16 v[28:29], v2 offset:256
    ds_read_b64_tr_b16 v[30:31], v2 offset:7936
    ds_read_b64 v[44:45], v3 offset:2048
    ds_read_b64 v[46:47], v5 offset:2048
    ds_read_b64_tr_b16 v[32:33], v2 offset:384
    ds_read_b64_tr_b16 v[34:35], v2 offset:8064
    ds_read_b64 v[48:49], v3 offset:3072
    ds_read_b64 v[50:51], v5 offset:3072
    s_waitcnt lgkmcnt(12)
    v_mfma_f32_16x16x32_bf16 v[52:55], v[20:23], v[36:39], v[52:55]
    s_waitcnt lgkmcnt(8)
    v_mfma_f32_16x16x32_bf16 v[68:71], v[24:27], v[36:39], v[68:71]
    v_mfma_f32_16x16x32_bf16 v[72:75], v[24:27], v[40:43], v[72:75]
    v_mfma_f32_16x16x32_bf16 v[56:59], v[20:23], v[40:43], v[56:59]
    s_waitcnt lgkmcnt(4)
    v_mfma_f32_16x16x32_bf16 v[84:87], v[28:31], v[36:39], v[84:87]
    v_mfma_f32_16x16x32_bf16 v[88:91], v[28:31], v[40:43], v[88:91]
    v_mfma_f32_16x16x32_bf16 v[92:95], v[28:31], v[44:47], v[92:95]
    v_mfma_f32_16x16x32_bf16 v[60:63], v[20:23], v[44:47], v[60:63]
    v_mfma_f32_16x16x32_bf16 v[76:79], v[24:27], v[44:47], v[76:79]
    s_waitcnt lgkmcnt(0)
    v_mfma_f32_16x16x32_bf16 v[100:103], v[32:35], v[36:39], v[100:103]
    v_mfma_f32_16x16x32_bf16 v[104:107], v[32:35], v[40:43], v[104:107]
    v_mfma_f32_16x16x32_bf16 v[108:111], v[32:35], v[44:47], v[108:111]
    v_mfma_f32_16x16x32_bf16 v[112:115], v[32:35], v[48:51], v[112:115]
    v_mfma_f32_16x16x32_bf16 v[64:67], v[20:23], v[48:51], v[64:67]
    v_mfma_f32_16x16x32_bf16 v[80:83], v[24:27], v[48:51], v[80:83]
    v_mfma_f32_16x16x32_bf16 v[96:99], v[28:31], v[48:51], v[96:99]
    s_barrier
    ds_read_b64_tr_b16 v[20:21], v2 offset:19456
    ds_read_b64_tr_b16 v[22:23], v2 offset:27136
    ds_read_b64 v[36:37], v3 offset:19456
    ds_read_b64 v[38:39], v5 offset:19456
    ds_read_b64_tr_b16 v[24:25], v2 offset:19584
    ds_read_b64_tr_b16 v[26:27], v2 offset:27264
    ds_read_b64 v[40:41], v3 offset:20480
    ds_read_b64 v[42:43], v5 offset:20480
    ds_read_b64_tr_b16 v[28:29], v2 offset:19712
    ds_read_b64_tr_b16 v[30:31], v2 offset:27392
    ds_read_b64 v[44:45], v3 offset:21504
    ds_read_b64 v[46:47], v5 offset:21504
    ds_read_b64_tr_b16 v[32:33], v2 offset:19840
    ds_read_b64_tr_b16 v[34:35], v2 offset:27520
    ds_read_b64 v[48:49], v3 offset:22528
    ds_read_b64 v[50:51], v5 offset:22528
    s_waitcnt lgkmcnt(12)
    v_mfma_f32_16x16x32_bf16 v[52:55], v[20:23], v[36:39], v[52:55]
    s_waitcnt lgkmcnt(8)
    v_mfma_f32_16x16x32_bf16 v[68:71], v[24:27], v[36:39], v[68:71]
    v_mfma_f32_16x16x32_bf16 v[72:75], v[24:27], v[40:43], v[72:75]
    v_mfma_f32_16x16x32_bf16 v[56:59], v[20:23], v[40:43], v[56:59]
    s_waitcnt lgkmcnt(4)
    v_mfma_f32_16x16x32_bf16 v[84:87], v[28:31], v[36:39], v[84:87]
    v_mfma_f32_16x16x32_bf16 v[88:91], v[28:31], v[40:43], v[88:91]
    v_mfma_f32_16x16x32_bf16 v[92:95], v[28:31], v[44:47], v[92:95]
    v_mfma_f32_16x16x32_bf16 v[60:63], v[20:23], v[44:47], v[60:63]
    v_mfma_f32_16x16x32_bf16 v[76:79], v[24:27], v[44:47], v[76:79]
    s_waitcnt lgkmcnt(0)
    v_mfma_f32_16x16x32_bf16 v[100:103], v[32:35], v[36:39], v[100:103]
    v_mfma_f32_16x16x32_bf16 v[104:107], v[32:35], v[40:43], v[104:107]
    v_mfma_f32_16x16x32_bf16 v[108:111], v[32:35], v[44:47], v[108:111]
    v_mfma_f32_16x16x32_bf16 v[112:115], v[32:35], v[48:51], v[112:115]
    v_mfma_f32_16x16x32_bf16 v[64:67], v[20:23], v[48:51], v[64:67]
    v_mfma_f32_16x16x32_bf16 v[80:83], v[24:27], v[48:51], v[80:83]
    v_mfma_f32_16x16x32_bf16 v[96:99], v[28:31], v[48:51], v[96:99]
    s_add_u32 s31, s31, 1
    s_cmp_lt_u32 s31, 5
    s_cbranch_scc1 L_a1_loop
    s_barrier
    s_waitcnt vmcnt(0)
    s_mov_b32 s60, 0x3fb8aa3b
    s_mov_b32 s61, 0xffff0000
    s_mov_b32 s62, 0x358637bd
    v_lshlrev_b32 v5, 3, v1
    v_mul_u32_u24 v6, 352, v19
    v_lshl_add_u32 v6, v16, 3, v6
    s_add_u32 s32, s4, 0
    s_cmp_ge_u32 s32, 10
    s_cbranch_scc1 L_a1_ep0_v
    v_cvt_pk_bf16_f32 v116, v52, v53
    v_lshlrev_b32 v117, 16, v116
    v_and_b32 v118, s61, v116
    v_mul_f32 v119, s60, v117
    v_mul_f32 v120, s60, v118
    v_exp_f32 v119, v119
    v_exp_f32 v120, v120
    v_add_f32 v121, 1.0, v117
    v_add_f32 v122, 1.0, v118
    v_cmp_lt_f32 vcc, 0, v117
    v_cmp_lt_f32 s[44:45], 0, v118
    s_nop 0
    v_cndmask_b32 v119, v119, v121, vcc
    v_cndmask_b32 v120, v120, v122, s[44:45]
    v_cvt_pk_bf16_f32 v116, v119, v120
    v_lshlrev_b32 v117, 16, v116
    v_and_b32 v118, s61, v116
    v_add_f32 v117, s62, v117
    v_add_f32 v118, s62, v118
    v_cvt_pk_bf16_f32 v20, v117, v118
    v_cvt_pk_bf16_f32 v8, v54, v55
    v_lshlrev_b32 v9, 16, v8
    v_and_b32 v10, s61, v8
    v_mul_f32 v11, s60, v9
    v_mul_f32 v12, s60, v10
    v_exp_f32 v11, v11
    v_exp_f32 v12, v12
    v_add_f32 v13, 1.0, v9
    v_add_f32 v14, 1.0, v10
    v_cmp_lt_f32 vcc, 0, v9
    v_cmp_lt_f32 s[44:45], 0, v10
    s_nop 0
    v_cndmask_b32 v11, v11, v13, vcc
    v_cndmask_b32 v12, v12, v14, s[44:45]
    v_cvt_pk_bf16_f32 v8, v11, v12
    v_lshlrev_b32 v9, 16, v8
    v_and_b32 v10, s61, v8
    v_add_f32 v9, s62, v9
    v_add_f32 v10, s62, v10
    v_cvt_pk_bf16_f32 v21, v9, v10
    v_cvt_pk_bf16_f32 v116, v56, v57
    v_lshlrev_b32 v117, 16, v116
    v_and_b32 v118, s61, v116
    v_mul_f32 v119, s60, v117
    v_mul_f32 v120, s60, v118
    v_exp_f32 v119, v119
    v_exp_f32 v120, v120
    v_add_f32 v121, 1.0, v117
    v_add_f32 v122, 1.0, v118
    v_cmp_lt_f32 vcc, 0, v117
    v_cmp_lt_f32 s[44:45], 0, v118
    s_nop 0
    v_cndmask_b32 v119, v119, v121, vcc
    v_cndmask_b32 v120, v120, v122, s[44:45]
    v_cvt_pk_bf16_f32 v116, v119, v120
    v_lshlrev_b32 v117, 16, v116
    v_and_b32 v118, s61, v116
    v_add_f32 v117, s62, v117
    v_add_f32 v118, s62, v118
    v_cvt_pk_bf16_f32 v22, v117, v118
    v_cvt_pk_bf16_f32 v8, v58, v59
    v_lshlrev_b32 v9, 16, v8
    v_and_b32 v10, s61, v8
    v_mul_f32 v11, s60, v9
    v_mul_f32 v12, s60, v10
    v_exp_f32 v11, v11
    v_exp_f32 v12, v12
    v_add_f32 v13, 1.0, v9
    v_add_f32 v14, 1.0, v10
    v_cmp_lt_f32 vcc, 0, v9
    v_cmp_lt_f32 s[44:45], 0, v10
    s_nop 0
    v_cndmask_b32 v11, v11, v13, vcc
    v_cndmask_b32 v12, v12, v14, s[44:45]
    v_cvt_pk_bf16_f32 v8, v11, v12
    v_lshlrev_b32 v9, 16, v8
    v_and_b32 v10, s61, v8
    v_add_f32 v9, s62, v9
    v_add_f32 v10, s62, v10
    v_cvt_pk_bf16_f32 v23, v9, v10
    v_cvt_pk_bf16_f32 v116, v60, v61
    v_lshlrev_b32 v117, 16, v116
    v_and_b32 v118, s61, v116
    v_mul_f32 v119, s60, v117
    v_mul_f32 v120, s60, v118
    v_exp_f32 v119, v119
    v_exp_f32 v120, v120
    v_add_f32 v121, 1.0, v117
    v_add_f32 v122, 1.0, v118
    v_cmp_lt_f32 vcc, 0, v117
    v_cmp_lt_f32 s[44:45], 0, v118
    s_nop 0
    v_cndmask_b32 v119, v119, v121, vcc
    v_cndmask_b32 v120, v120, v122, s[44:45]
    v_cvt_pk_bf16_f32 v116, v119, v120
    v_lshlrev_b32 v117, 16, v116
    v_and_b32 v118, s61, v116
    v_add_f32 v117, s62, v117
    v_add_f32 v118, s62, v118
    v_cvt_pk_bf16_f32 v24, v117, v118
    v_cvt_pk_bf16_f32 v8, v62, v63
    v_lshlrev_b32 v9, 16, v8
    v_and_b32 v10, s61, v8
    v_mul_f32 v11, s60, v9
    v_mul_f32 v12, s60, v10
    v_exp_f32 v11, v11
    v_exp_f32 v12, v12
    v_add_f32 v13, 1.0, v9
    v_add_f32 v14, 1.0, v10
    v_cmp_lt_f32 vcc, 0, v9
    v_cmp_lt_f32 s[44:45], 0, v10
    s_nop 0
    v_cndmask_b32 v11, v11, v13, vcc
    v_cndmask_b32 v12, v12, v14, s[44:45]
    v_cvt_pk_bf16_f32 v8, v11, v12
    v_lshlrev_b32 v9, 16, v8
    v_and_b32 v10, s61, v8
    v_add_f32 v9, s62, v9
    v_add_f32 v10, s62, v10
    v_cvt_pk_bf16_f32 v25, v9, v10
    v_cvt_pk_bf16_f32 v116, v64, v65
    v_lshlrev_b32 v117, 16, v116
    v_and_b32 v118, s61, v116
    v_mul_f32 v119, s60, v117
    v_mul_f32 v120, s60, v118
    v_exp_f32 v119, v119
    v_exp_f32 v120, v120
    v_add_f32 v121, 1.0, v117
    v_add_f32 v122, 1.0, v118
    v_cmp_lt_f32 vcc, 0, v117
    v_cmp_lt_f32 s[44:45], 0, v118
    s_nop 0
    v_cndmask_b32 v119, v119, v121, vcc
    v_cndmask_b32 v120, v120, v122, s[44:45]
    v_cvt_pk_bf16_f32 v116, v119, v120
    v_lshlrev_b32 v117, 16, v116
    v_and_b32 v118, s61, v116
    v_add_f32 v117, s62, v117
    v_add_f32 v118, s62, v118
    v_cvt_pk_bf16_f32 v26, v117, v118
    v_cvt_pk_bf16_f32 v8, v66, v67
    v_lshlrev_b32 v9, 16, v8
    v_and_b32 v10, s61, v8
    v_mul_f32 v11, s60, v9
    v_mul_f32 v12, s60, v10
    v_exp_f32 v11, v11
    v_exp_f32 v12, v12
    v_add_f32 v13, 1.0, v9
    v_add_f32 v14, 1.0, v10
    v_cmp_lt_f32 vcc, 0, v9
    v_cmp_lt_f32 s[44:45], 0, v10
    s_nop 0
    v_cndmask_b32 v11, v11, v13, vcc
    v_cndmask_b32 v12, v12, v14, s[44:45]
    v_cvt_pk_bf16_f32 v8, v11, v12
    v_lshlrev_b32 v9, 16, v8
    v_and_b32 v10, s61, v8
    v_add_f32 v9, s62, v9
    v_add_f32 v10, s62, v10
    v_cvt_pk_bf16_f32 v27, v9, v10
    s_branch L_a1_ep0_done
L_a1_ep0_v:
    v_cvt_pk_bf16_f32 v20, v52, v53
    v_cvt_pk_bf16_f32 v21, v54, v55
    v_cvt_pk_bf16_f32 v22, v56, v57
    v_cvt_pk_bf16_f32 v23, v58, v59
    v_cvt_pk_bf16_f32 v24, v60, v61
    v_cvt_pk_bf16_f32 v25, v62, v63
    v_cvt_pk_bf16_f32 v26, v64, v65
    v_cvt_pk_bf16_f32 v27, v66, v67
L_a1_ep0_done:
    s_add_u32 s32, s4, 4
    s_cmp_ge_u32 s32, 10
    s_cbranch_scc1 L_a1_ep1_v
    v_cvt_pk_bf16_f32 v116, v68, v69
    v_lshlrev_b32 v117, 16, v116
    v_and_b32 v118, s61, v116
    v_mul_f32 v119, s60, v117
    v_mul_f32 v120, s60, v118
    v_exp_f32 v119, v119
    v_exp_f32 v120, v120
    v_add_f32 v121, 1.0, v117
    v_add_f32 v122, 1.0, v118
    v_cmp_lt_f32 vcc, 0, v117
    v_cmp_lt_f32 s[44:45], 0, v118
    s_nop 0
    v_cndmask_b32 v119, v119, v121, vcc
    v_cndmask_b32 v120, v120, v122, s[44:45]
    v_cvt_pk_bf16_f32 v116, v119, v120
    v_lshlrev_b32 v117, 16, v116
    v_and_b32 v118, s61, v116
    v_add_f32 v117, s62, v117
    v_add_f32 v118, s62, v118
    v_cvt_pk_bf16_f32 v28, v117, v118
    v_cvt_pk_bf16_f32 v8, v70, v71
    v_lshlrev_b32 v9, 16, v8
    v_and_b32 v10, s61, v8
    v_mul_f32 v11, s60, v9
    v_mul_f32 v12, s60, v10
    v_exp_f32 v11, v11
    v_exp_f32 v12, v12
    v_add_f32 v13, 1.0, v9
    v_add_f32 v14, 1.0, v10
    v_cmp_lt_f32 vcc, 0, v9
    v_cmp_lt_f32 s[44:45], 0, v10
    s_nop 0
    v_cndmask_b32 v11, v11, v13, vcc
    v_cndmask_b32 v12, v12, v14, s[44:45]
    v_cvt_pk_bf16_f32 v8, v11, v12
    v_lshlrev_b32 v9, 16, v8
    v_and_b32 v10, s61, v8
    v_add_f32 v9, s62, v9
    v_add_f32 v10, s62, v10
    v_cvt_pk_bf16_f32 v29, v9, v10
    v_cvt_pk_bf16_f32 v116, v72, v73
    v_lshlrev_b32 v117, 16, v116
    v_and_b32 v118, s61, v116
    v_mul_f32 v119, s60, v117
    v_mul_f32 v120, s60, v118
    v_exp_f32 v119, v119
    v_exp_f32 v120, v120
    v_add_f32 v121, 1.0, v117
    v_add_f32 v122, 1.0, v118
    v_cmp_lt_f32 vcc, 0, v117
    v_cmp_lt_f32 s[44:45], 0, v118
    s_nop 0
    v_cndmask_b32 v119, v119, v121, vcc
    v_cndmask_b32 v120, v120, v122, s[44:45]
    v_cvt_pk_bf16_f32 v116, v119, v120
    v_lshlrev_b32 v117, 16, v116
    v_and_b32 v118, s61, v116
    v_add_f32 v117, s62, v117
    v_add_f32 v118, s62, v118
    v_cvt_pk_bf16_f32 v30, v117, v118
    v_cvt_pk_bf16_f32 v8, v74, v75
    v_lshlrev_b32 v9, 16, v8
    v_and_b32 v10, s61, v8
    v_mul_f32 v11, s60, v9
    v_mul_f32 v12, s60, v10
    v_exp_f32 v11, v11
    v_exp_f32 v12, v12
    v_add_f32 v13, 1.0, v9
    v_add_f32 v14, 1.0, v10
    v_cmp_lt_f32 vcc, 0, v9
    v_cmp_lt_f32 s[44:45], 0, v10
    s_nop 0
    v_cndmask_b32 v11, v11, v13, vcc
    v_cndmask_b32 v12, v12, v14, s[44:45]
    v_cvt_pk_bf16_f32 v8, v11, v12
    v_lshlrev_b32 v9, 16, v8
    v_and_b32 v10, s61, v8
    v_add_f32 v9, s62, v9
    v_add_f32 v10, s62, v10
    v_cvt_pk_bf16_f32 v31, v9, v10
    v_cvt_pk_bf16_f32 v116, v76, v77
    v_lshlrev_b32 v117, 16, v116
    v_and_b32 v118, s61, v116
    v_mul_f32 v119, s60, v117
    v_mul_f32 v120, s60, v118
    v_exp_f32 v119, v119
    v_exp_f32 v120, v120
    v_add_f32 v121, 1.0, v117
    v_add_f32 v122, 1.0, v118
    v_cmp_lt_f32 vcc, 0, v117
    v_cmp_lt_f32 s[44:45], 0, v118
    s_nop 0
    v_cndmask_b32 v119, v119, v121, vcc
    v_cndmask_b32 v120, v120, v122, s[44:45]
    v_cvt_pk_bf16_f32 v116, v119, v120
    v_lshlrev_b32 v117, 16, v116
    v_and_b32 v118, s61, v116
    v_add_f32 v117, s62, v117
    v_add_f32 v118, s62, v118
    v_cvt_pk_bf16_f32 v32, v117, v118
    v_cvt_pk_bf16_f32 v8, v78, v79
    v_lshlrev_b32 v9, 16, v8
    v_and_b32 v10, s61, v8
    v_mul_f32 v11, s60, v9
    v_mul_f32 v12, s60, v10
    v_exp_f32 v11, v11
    v_exp_f32 v12, v12
    v_add_f32 v13, 1.0, v9
    v_add_f32 v14, 1.0, v10
    v_cmp_lt_f32 vcc, 0, v9
    v_cmp_lt_f32 s[44:45], 0, v10
    s_nop 0
    v_cndmask_b32 v11, v11, v13, vcc
    v_cndmask_b32 v12, v12, v14, s[44:45]
    v_cvt_pk_bf16_f32 v8, v11, v12
    v_lshlrev_b32 v9, 16, v8
    v_and_b32 v10, s61, v8
    v_add_f32 v9, s62, v9
    v_add_f32 v10, s62, v10
    v_cvt_pk_bf16_f32 v33, v9, v10
    v_cvt_pk_bf16_f32 v116, v80, v81
    v_lshlrev_b32 v117, 16, v116
    v_and_b32 v118, s61, v116
    v_mul_f32 v119, s60, v117
    v_mul_f32 v120, s60, v118
    v_exp_f32 v119, v119
    v_exp_f32 v120, v120
    v_add_f32 v121, 1.0, v117
    v_add_f32 v122, 1.0, v118
    v_cmp_lt_f32 vcc, 0, v117
    v_cmp_lt_f32 s[44:45], 0, v118
    s_nop 0
    v_cndmask_b32 v119, v119, v121, vcc
    v_cndmask_b32 v120, v120, v122, s[44:45]
    v_cvt_pk_bf16_f32 v116, v119, v120
    v_lshlrev_b32 v117, 16, v116
    v_and_b32 v118, s61, v116
    v_add_f32 v117, s62, v117
    v_add_f32 v118, s62, v118
    v_cvt_pk_bf16_f32 v34, v117, v118
    v_cvt_pk_bf16_f32 v8, v82, v83
    v_lshlrev_b32 v9, 16, v8
    v_and_b32 v10, s61, v8
    v_mul_f32 v11, s60, v9
    v_mul_f32 v12, s60, v10
    v_exp_f32 v11, v11
    v_exp_f32 v12, v12
    v_add_f32 v13, 1.0, v9
    v_add_f32 v14, 1.0, v10
    v_cmp_lt_f32 vcc, 0, v9
    v_cmp_lt_f32 s[44:45], 0, v10
    s_nop 0
    v_cndmask_b32 v11, v11, v13, vcc
    v_cndmask_b32 v12, v12, v14, s[44:45]
    v_cvt_pk_bf16_f32 v8, v11, v12
    v_lshlrev_b32 v9, 16, v8
    v_and_b32 v10, s61, v8
    v_add_f32 v9, s62, v9
    v_add_f32 v10, s62, v10
    v_cvt_pk_bf16_f32 v35, v9, v10
    s_branch L_a1_ep1_done
L_a1_ep1_v:
    v_cvt_pk_bf16_f32 v28, v68, v69
    v_cvt_pk_bf16_f32 v29, v70, v71
    v_cvt_pk_bf16_f32 v30, v72, v73
    v_cvt_pk_bf16_f32 v31, v74, v75
    v_cvt_pk_bf16_f32 v32, v76, v77
    v_cvt_pk_bf16_f32 v33, v78, v79
    v_cvt_pk_bf16_f32 v34, v80, v81
    v_cvt_pk_bf16_f32 v35, v82, v83
L_a1_ep1_done:
    s_add_u32 s32, s4, 8
    s_cmp_ge_u32 s32, 10
    s_cbranch_scc1 L_a1_ep2_v
    v_cvt_pk_bf16_f32 v116, v84, v85
    v_lshlrev_b32 v117, 16, v116
    v_and_b32 v118, s61, v116
    v_mul_f32 v119, s60, v117
    v_mul_f32 v120, s60, v118
    v_exp_f32 v119, v119
    v_exp_f32 v120, v120
    v_add_f32 v121, 1.0, v117
    v_add_f32 v122, 1.0, v118
    v_cmp_lt_f32 vcc, 0, v117
    v_cmp_lt_f32 s[44:45], 0, v118
    s_nop 0
    v_cndmask_b32 v119, v119, v121, vcc
    v_cndmask_b32 v120, v120, v122, s[44:45]
    v_cvt_pk_bf16_f32 v116, v119, v120
    v_lshlrev_b32 v117, 16, v116
    v_and_b32 v118, s61, v116
    v_add_f32 v117, s62, v117
    v_add_f32 v118, s62, v118
    v_cvt_pk_bf16_f32 v36, v117, v118
    v_cvt_pk_bf16_f32 v8, v86, v87
    v_lshlrev_b32 v9, 16, v8
    v_and_b32 v10, s61, v8
    v_mul_f32 v11, s60, v9
    v_mul_f32 v12, s60, v10
    v_exp_f32 v11, v11
    v_exp_f32 v12, v12
    v_add_f32 v13, 1.0, v9
    v_add_f32 v14, 1.0, v10
    v_cmp_lt_f32 vcc, 0, v9
    v_cmp_lt_f32 s[44:45], 0, v10
    s_nop 0
    v_cndmask_b32 v11, v11, v13, vcc
    v_cndmask_b32 v12, v12, v14, s[44:45]
    v_cvt_pk_bf16_f32 v8, v11, v12
    v_lshlrev_b32 v9, 16, v8
    v_and_b32 v10, s61, v8
    v_add_f32 v9, s62, v9
    v_add_f32 v10, s62, v10
    v_cvt_pk_bf16_f32 v37, v9, v10
    v_cvt_pk_bf16_f32 v116, v88, v89
    v_lshlrev_b32 v117, 16, v116
    v_and_b32 v118, s61, v116
    v_mul_f32 v119, s60, v117
    v_mul_f32 v120, s60, v118
    v_exp_f32 v119, v119
    v_exp_f32 v120, v120
    v_add_f32 v121, 1.0, v117
    v_add_f32 v122, 1.0, v118
    v_cmp_lt_f32 vcc, 0, v117
    v_cmp_lt_f32 s[44:45], 0, v118
    s_nop 0
    v_cndmask_b32 v119, v119, v121, vcc
    v_cndmask_b32 v120, v120, v122, s[44:45]
    v_cvt_pk_bf16_f32 v116, v119, v120
    v_lshlrev_b32 v117, 16, v116
    v_and_b32 v118, s61, v116
    v_add_f32 v117, s62, v117
    v_add_f32 v118, s62, v118
    v_cvt_pk_bf16_f32 v38, v117, v118
    v_cvt_pk_bf16_f32 v8, v90, v91
    v_lshlrev_b32 v9, 16, v8
    v_and_b32 v10, s61, v8
    v_mul_f32 v11, s60, v9
    v_mul_f32 v12, s60, v10
    v_exp_f32 v11, v11
    v_exp_f32 v12, v12
    v_add_f32 v13, 1.0, v9
    v_add_f32 v14, 1.0, v10
    v_cmp_lt_f32 vcc, 0, v9
    v_cmp_lt_f32 s[44:45], 0, v10
    s_nop 0
    v_cndmask_b32 v11, v11, v13, vcc
    v_cndmask_b32 v12, v12, v14, s[44:45]
    v_cvt_pk_bf16_f32 v8, v11, v12
    v_lshlrev_b32 v9, 16, v8
    v_and_b32 v10, s61, v8
    v_add_f32 v9, s62, v9
    v_add_f32 v10, s62, v10
    v_cvt_pk_bf16_f32 v39, v9, v10
    v_cvt_pk_bf16_f32 v116, v92, v93
    v_lshlrev_b32 v117, 16, v116
    v_and_b32 v118, s61, v116
    v_mul_f32 v119, s60, v117
    v_mul_f32 v120, s60, v118
    v_exp_f32 v119, v119
    v_exp_f32 v120, v120
    v_add_f32 v121, 1.0, v117
    v_add_f32 v122, 1.0, v118
    v_cmp_lt_f32 vcc, 0, v117
    v_cmp_lt_f32 s[44:45], 0, v118
    s_nop 0
    v_cndmask_b32 v119, v119, v121, vcc
    v_cndmask_b32 v120, v120, v122, s[44:45]
    v_cvt_pk_bf16_f32 v116, v119, v120
    v_lshlrev_b32 v117, 16, v116
    v_and_b32 v118, s61, v116
    v_add_f32 v117, s62, v117
    v_add_f32 v118, s62, v118
    v_cvt_pk_bf16_f32 v40, v117, v118
    v_cvt_pk_bf16_f32 v8, v94, v95
    v_lshlrev_b32 v9, 16, v8
    v_and_b32 v10, s61, v8
    v_mul_f32 v11, s60, v9
    v_mul_f32 v12, s60, v10
    v_exp_f32 v11, v11
    v_exp_f32 v12, v12
    v_add_f32 v13, 1.0, v9
    v_add_f32 v14, 1.0, v10
    v_cmp_lt_f32 vcc, 0, v9
    v_cmp_lt_f32 s[44:45], 0, v10
    s_nop 0
    v_cndmask_b32 v11, v11, v13, vcc
    v_cndmask_b32 v12, v12, v14, s[44:45]
    v_cvt_pk_bf16_f32 v8, v11, v12
    v_lshlrev_b32 v9, 16, v8
    v_and_b32 v10, s61, v8
    v_add_f32 v9, s62, v9
    v_add_f32 v10, s62, v10
    v_cvt_pk_bf16_f32 v41, v9, v10
    v_cvt_pk_bf16_f32 v116, v96, v97
    v_lshlrev_b32 v117, 16, v116
    v_and_b32 v118, s61, v116
    v_mul_f32 v119, s60, v117
    v_mul_f32 v120, s60, v118
    v_exp_f32 v119, v119
    v_exp_f32 v120, v120
    v_add_f32 v121, 1.0, v117
    v_add_f32 v122, 1.0, v118
    v_cmp_lt_f32 vcc, 0, v117
    v_cmp_lt_f32 s[44:45], 0, v118
    s_nop 0
    v_cndmask_b32 v119, v119, v121, vcc
    v_cndmask_b32 v120, v120, v122, s[44:45]
    v_cvt_pk_bf16_f32 v116, v119, v120
    v_lshlrev_b32 v117, 16, v116
    v_and_b32 v118, s61, v116
    v_add_f32 v117, s62, v117
    v_add_f32 v118, s62, v118
    v_cvt_pk_bf16_f32 v42, v117, v118
    v_cvt_pk_bf16_f32 v8, v98, v99
    v_lshlrev_b32 v9, 16, v8
    v_and_b32 v10, s61, v8
    v_mul_f32 v11, s60, v9
    v_mul_f32 v12, s60, v10
    v_exp_f32 v11, v11
    v_exp_f32 v12, v12
    v_add_f32 v13, 1.0, v9
    v_add_f32 v14, 1.0, v10
    v_cmp_lt_f32 vcc, 0, v9
    v_cmp_lt_f32 s[44:45], 0, v10
    s_nop 0
    v_cndmask_b32 v11, v11, v13, vcc
    v_cndmask_b32 v12, v12, v14, s[44:45]
    v_cvt_pk_bf16_f32 v8, v11, v12
    v_lshlrev_b32 v9, 16, v8
    v_and_b32 v10, s61, v8
    v_add_f32 v9, s62, v9
    v_add_f32 v10, s62, v10
    v_cvt_pk_bf16_f32 v43, v9, v10
    s_branch L_a1_ep2_done
L_a1_ep2_v:
    v_cvt_pk_bf16_f32 v36, v84, v85
    v_cvt_pk_bf16_f32 v37, v86, v87
    v_cvt_pk_bf16_f32 v38, v88, v89
    v_cvt_pk_bf16_f32 v39, v90, v91
    v_cvt_pk_bf16_f32 v40, v92, v93
    v_cvt_pk_bf16_f32 v41, v94, v95
    v_cvt_pk_bf16_f32 v42, v96, v97
    v_cvt_pk_bf16_f32 v43, v98, v99
L_a1_ep2_done:
    s_add_u32 s32, s4, 12
    s_cmp_ge_u32 s32, 10
    s_cbranch_scc1 L_a1_ep3_v
    v_cvt_pk_bf16_f32 v116, v100, v101
    v_lshlrev_b32 v117, 16, v116
    v_and_b32 v118, s61, v116
    v_mul_f32 v119, s60, v117
    v_mul_f32 v120, s60, v118
    v_exp_f32 v119, v119
    v_exp_f32 v120, v120
    v_add_f32 v121, 1.0, v117
    v_add_f32 v122, 1.0, v118
    v_cmp_lt_f32 vcc, 0, v117
    v_cmp_lt_f32 s[44:45], 0, v118
    s_nop 0
    v_cndmask_b32 v119, v119, v121, vcc
    v_cndmask_b32 v120, v120, v122, s[44:45]
    v_cvt_pk_bf16_f32 v116, v119, v120
    v_lshlrev_b32 v117, 16, v116
    v_and_b32 v118, s61, v116
    v_add_f32 v117, s62, v117
    v_add_f32 v118, s62, v118
    v_cvt_pk_bf16_f32 v44, v117, v118
    v_cvt_pk_bf16_f32 v8, v102, v103
    v_lshlrev_b32 v9, 16, v8
    v_and_b32 v10, s61, v8
    v_mul_f32 v11, s60, v9
    v_mul_f32 v12, s60, v10
    v_exp_f32 v11, v11
    v_exp_f32 v12, v12
    v_add_f32 v13, 1.0, v9
    v_add_f32 v14, 1.0, v10
    v_cmp_lt_f32 vcc, 0, v9
    v_cmp_lt_f32 s[44:45], 0, v10
    s_nop 0
    v_cndmask_b32 v11, v11, v13, vcc
    v_cndmask_b32 v12, v12, v14, s[44:45]
    v_cvt_pk_bf16_f32 v8, v11, v12
    v_lshlrev_b32 v9, 16, v8
    v_and_b32 v10, s61, v8
    v_add_f32 v9, s62, v9
    v_add_f32 v10, s62, v10
    v_cvt_pk_bf16_f32 v45, v9, v10
    v_cvt_pk_bf16_f32 v116, v104, v105
    v_lshlrev_b32 v117, 16, v116
    v_and_b32 v118, s61, v116
    v_mul_f32 v119, s60, v117
    v_mul_f32 v120, s60, v118
    v_exp_f32 v119, v119
    v_exp_f32 v120, v120
    v_add_f32 v121, 1.0, v117
    v_add_f32 v122, 1.0, v118
    v_cmp_lt_f32 vcc, 0, v117
    v_cmp_lt_f32 s[44:45], 0, v118
    s_nop 0
    v_cndmask_b32 v119, v119, v121, vcc
    v_cndmask_b32 v120, v120, v122, s[44:45]
    v_cvt_pk_bf16_f32 v116, v119, v120
    v_lshlrev_b32 v117, 16, v116
    v_and_b32 v118, s61, v116
    v_add_f32 v117, s62, v117
    v_add_f32 v118, s62, v118
    v_cvt_pk_bf16_f32 v46, v117, v118
    v_cvt_pk_bf16_f32 v8, v106, v107
    v_lshlrev_b32 v9, 16, v8
    v_and_b32 v10, s61, v8
    v_mul_f32 v11, s60, v9
    v_mul_f32 v12, s60, v10
    v_exp_f32 v11, v11
    v_exp_f32 v12, v12
    v_add_f32 v13, 1.0, v9
    v_add_f32 v14, 1.0, v10
    v_cmp_lt_f32 vcc, 0, v9
    v_cmp_lt_f32 s[44:45], 0, v10
    s_nop 0
    v_cndmask_b32 v11, v11, v13, vcc
    v_cndmask_b32 v12, v12, v14, s[44:45]
    v_cvt_pk_bf16_f32 v8, v11, v12
    v_lshlrev_b32 v9, 16, v8
    v_and_b32 v10, s61, v8
    v_add_f32 v9, s62, v9
    v_add_f32 v10, s62, v10
    v_cvt_pk_bf16_f32 v47, v9, v10
    v_cvt_pk_bf16_f32 v116, v108, v109
    v_lshlrev_b32 v117, 16, v116
    v_and_b32 v118, s61, v116
    v_mul_f32 v119, s60, v117
    v_mul_f32 v120, s60, v118
    v_exp_f32 v119, v119
    v_exp_f32 v120, v120
    v_add_f32 v121, 1.0, v117
    v_add_f32 v122, 1.0, v118
    v_cmp_lt_f32 vcc, 0, v117
    v_cmp_lt_f32 s[44:45], 0, v118
    s_nop 0
    v_cndmask_b32 v119, v119, v121, vcc
    v_cndmask_b32 v120, v120, v122, s[44:45]
    v_cvt_pk_bf16_f32 v116, v119, v120
    v_lshlrev_b32 v117, 16, v116
    v_and_b32 v118, s61, v116
    v_add_f32 v117, s62, v117
    v_add_f32 v118, s62, v118
    v_cvt_pk_bf16_f32 v48, v117, v118
    v_cvt_pk_bf16_f32 v8, v110, v111
    v_lshlrev_b32 v9, 16, v8
    v_and_b32 v10, s61, v8
    v_mul_f32 v11, s60, v9
    v_mul_f32 v12, s60, v10
    v_exp_f32 v11, v11
    v_exp_f32 v12, v12
    v_add_f32 v13, 1.0, v9
    v_add_f32 v14, 1.0, v10
    v_cmp_lt_f32 vcc, 0, v9
    v_cmp_lt_f32 s[44:45], 0, v10
    s_nop 0
    v_cndmask_b32 v11, v11, v13, vcc
    v_cndmask_b32 v12, v12, v14, s[44:45]
    v_cvt_pk_bf16_f32 v8, v11, v12
    v_lshlrev_b32 v9, 16, v8
    v_and_b32 v10, s61, v8
    v_add_f32 v9, s62, v9
    v_add_f32 v10, s62, v10
    v_cvt_pk_bf16_f32 v49, v9, v10
    v_cvt_pk_bf16_f32 v116, v112, v113
    v_lshlrev_b32 v117, 16, v116
    v_and_b32 v118, s61, v116
    v_mul_f32 v119, s60, v117
    v_mul_f32 v120, s60, v118
    v_exp_f32 v119, v119
    v_exp_f32 v120, v120
    v_add_f32 v121, 1.0, v117
    v_add_f32 v122, 1.0, v118
    v_cmp_lt_f32 vcc, 0, v117
    v_cmp_lt_f32 s[44:45], 0, v118
    s_nop 0
    v_cndmask_b32 v119, v119, v121, vcc
    v_cndmask_b32 v120, v120, v122, s[44:45]
    v_cvt_pk_bf16_f32 v116, v119, v120
    v_lshlrev_b32 v117, 16, v116
    v_and_b32 v118, s61, v116
    v_add_f32 v117, s62, v117
    v_add_f32 v118, s62, v118
    v_cvt_pk_bf16_f32 v50, v117, v118
    v_cvt_pk_bf16_f32 v8, v114, v115
    v_lshlrev_b32 v9, 16, v8
    v_and_b32 v10, s61, v8
    v_mul_f32 v11, s60, v9
    v_mul_f32 v12, s60, v10
    v_exp_f32 v11, v11
    v_exp_f32 v12, v12
    v_add_f32 v13, 1.0, v9
    v_add_f32 v14, 1.0, v10
    v_cmp_lt_f32 vcc, 0, v9
    v_cmp_lt_f32 s[44:45], 0, v10
    s_nop 0
    v_cndmask_b32 v11, v11, v13, vcc
    v_cndmask_b32 v12, v12, v14, s[44:45]
    v_cvt_pk_bf16_f32 v8, v11, v12
    v_lshlrev_b32 v9, 16, v8
    v_and_b32 v10, s61, v8
    v_add_f32 v9, s62, v9
    v_add_f32 v10, s62, v10
    v_cvt_pk_bf16_f32 v51, v9, v10
    s_branch L_a1_ep3_done
L_a1_ep3_v:
    v_cvt_pk_bf16_f32 v44, v100, v101
    v_cvt_pk_bf16_f32 v45, v102, v103
    v_cvt_pk_bf16_f32 v46, v104, v105
    v_cvt_pk_bf16_f32 v47, v106, v107
    v_cvt_pk_bf16_f32 v48, v108, v109
    v_cvt_pk_bf16_f32 v49, v110, v111
    v_cvt_pk_bf16_f32 v50, v112, v113
    v_cvt_pk_bf16_f32 v51, v114, v115
L_a1_ep3_done:
    s_add_u32 s32, s4, 0
    s_cmp_ge_u32 s32, 15
    s_cbranch_scc1 L_a1_st0_done
    s_cmp_ge_u32 s32, 5
    s_cbranch_scc1 L_a1_st0_lds
    s_mul_i32 s35, s6, 5
    s_add_u32 s35, s35, s32
    s_lshl_b32 s35, s35, 9
    s_mul_i32 s36, s5, 81920
    s_add_u32 s35, s35, s36
    s_add_u32 s36, s35, 0
    buffer_store_dwordx2 v[20:21], v5, s[24:27], s36 offen
    s_add_u32 s36, s35, 20480
    buffer_store_dwordx2 v[22:23], v5, s[24:27], s36 offen
    s_add_u32 s36, s35, 40960
    buffer_store_dwordx2 v[24:25], v5, s[24:27], s36 offen
    s_add_u32 s36, s35, 61440
    buffer_store_dwordx2 v[26:27], v5, s[24:27], s36 offen
    s_branch L_a1_st0_done
L_a1_st0_lds:
    s_sub_u32 s35, s32, 5
    s_lshl_b32 s35, s35, 5
    v_add_u32 v7, s35, v6
    ds_write_b64 v7, v[20:21] offset:0
    ds_write_b64 v7, v[22:23] offset:5632
    ds_write_b64 v7, v[24:25] offset:11264
    ds_write_b64 v7, v[26:27] offset:16896
L_a1_st0_done:
    s_add_u32 s32, s4, 4
    s_cmp_ge_u32 s32, 15
    s_cbranch_scc1 L_a1_st1_done
    s_cmp_ge_u32 s32, 5
    s_cbranch_scc1 L_a1_st1_lds
    s_mul_i32 s35, s6, 5
    s_add_u32 s35, s35, s32
    s_lshl_b32 s35, s35, 9
    s_mul_i32 s36, s5, 81920
    s_add_u32 s35, s35, s36
    s_add_u32 s36, s35, 0
    buffer_store_dwordx2 v[28:29], v5, s[24:27], s36 offen
    s_add_u32 s36, s35, 20480
    buffer_store_dwordx2 v[30:31], v5, s[24:27], s36 offen
    s_add_u32 s36, s35, 40960
    buffer_store_dwordx2 v[32:33], v5, s[24:27], s36 offen
    s_add_u32 s36, s35, 61440
    buffer_store_dwordx2 v[34:35], v5, s[24:27], s36 offen
    s_branch L_a1_st1_done
L_a1_st1_lds:
    s_sub_u32 s35, s32, 5
    s_lshl_b32 s35, s35, 5
    v_add_u32 v7, s35, v6
    ds_write_b64 v7, v[28:29] offset:0
    ds_write_b64 v7, v[30:31] offset:5632
    ds_write_b64 v7, v[32:33] offset:11264
    ds_write_b64 v7, v[34:35] offset:16896
L_a1_st1_done:
    s_add_u32 s32, s4, 8
    s_cmp_ge_u32 s32, 15
    s_cbranch_scc1 L_a1_st2_done
    s_cmp_ge_u32 s32, 5
    s_cbranch_scc1 L_a1_st2_lds
    s_mul_i32 s35, s6, 5
    s_add_u32 s35, s35, s32
    s_lshl_b32 s35, s35, 9
    s_mul_i32 s36, s5, 81920
    s_add_u32 s35, s35, s36
    s_add_u32 s36, s35, 0
    buffer_store_dwordx2 v[36:37], v5, s[24:27], s36 offen
    s_add_u32 s36, s35, 20480
    buffer_store_dwordx2 v[38:39], v5, s[24:27], s36 offen
    s_add_u32 s36, s35, 40960
    buffer_store_dwordx2 v[40:41], v5, s[24:27], s36 offen
    s_add_u32 s36, s35, 61440
    buffer_store_dwordx2 v[42:43], v5, s[24:27], s36 offen
    s_branch L_a1_st2_done
L_a1_st2_lds:
    s_sub_u32 s35, s32, 5
    s_lshl_b32 s35, s35, 5
    v_add_u32 v7, s35, v6
    ds_write_b64 v7, v[36:37] offset:0
    ds_write_b64 v7, v[38:39] offset:5632
    ds_write_b64 v7, v[40:41] offset:11264
    ds_write_b64 v7, v[42:43] offset:16896
L_a1_st2_done:
    s_add_u32 s32, s4, 12
    s_cmp_ge_u32 s32, 15
    s_cbranch_scc1 L_a1_st3_done
    s_cmp_ge_u32 s32, 5
    s_cbranch_scc1 L_a1_st3_lds
    s_mul_i32 s35, s6, 5
    s_add_u32 s35, s35, s32
    s_lshl_b32 s35, s35, 9
    s_mul_i32 s36, s5, 81920
    s_add_u32 s35, s35, s36
    s_add_u32 s36, s35, 0
    buffer_store_dwordx2 v[44:45], v5, s[24:27], s36 offen
    s_add_u32 s36, s35, 20480
    buffer_store_dwordx2 v[46:47], v5, s[24:27], s36 offen
    s_add_u32 s36, s35, 40960
    buffer_store_dwordx2 v[48:49], v5, s[24:27], s36 offen
    s_add_u32 s36, s35, 61440
    buffer_store_dwordx2 v[50:51], v5, s[24:27], s36 offen
    s_branch L_a1_st3_done
L_a1_st3_lds:
    s_sub_u32 s35, s32, 5
    s_lshl_b32 s35, s35, 5
    v_add_u32 v7, s35, v6
    ds_write_b64 v7, v[44:45] offset:0
    ds_write_b64 v7, v[46:47] offset:5632
    ds_write_b64 v7, v[48:49] offset:11264
    ds_write_b64 v7, v[50:51] offset:16896
L_a1_st3_done:
    s_waitcnt lgkmcnt(0)
    s_barrier
    v_lshl_add_u32 v13, v16, 2, v17
    v_mul_u32_u24 v13, 352, v13
    v_lshl_add_u32 v13, v18, 3, v13
    s_mul_i32 s35, s4, 40
    v_add_u32 v13, s35, v13
    ds_read_b64_tr_b16 v[32:33], v13 offset:0
    ds_read_b64_tr_b16 v[34:35], v13 offset:5632
    ds_read_b64_tr_b16 v[48:49], v13 offset:160
    ds_read_b64_tr_b16 v[50:51], v13 offset:5792
    ds_read_b64_tr_b16 v[36:37], v13 offset:32
    ds_read_b64_tr_b16 v[38:39], v13 offset:5664
    ds_read_b64_tr_b16 v[52:53], v13 offset:192
    ds_read_b64_tr_b16 v[54:55], v13 offset:5824
    ds_read_b64_tr_b16 v[40:41], v13 offset:11264
    ds_read_b64_tr_b16 v[42:43], v13 offset:16896
    ds_read_b64_tr_b16 v[56:57], v13 offset:11424
    ds_read_b64_tr_b16 v[58:59], v13 offset:17056
    ds_read_b64_tr_b16 v[44:45], v13 offset:11296
    ds_read_b64_tr_b16 v[46:47], v13 offset:16928
    ds_read_b64_tr_b16 v[60:61], v13 offset:11456
    ds_read_b64_tr_b16 v[62:63], v13 offset:17088
    v_cmp_eq_u32 vcc, 4, v19
    v_mov_b32 v24, 0x3f803f80
    s_waitcnt lgkmcnt(0)
    v_cndmask_b32 v52, v52, v24, vcc
    v_cndmask_b32 v53, v53, v24, vcc
    v_cndmask_b32 v54, v54, v24, vcc
    v_cndmask_b32 v55, v55, v24, vcc
    v_cndmask_b32 v60, v60, v24, vcc
    v_cndmask_b32 v61, v61, v24, vcc
    v_cndmask_b32 v62, v62, v24, vcc
    v_cndmask_b32 v63, v63, v24, vcc
    v_mfma_f32_16x16x32_bf16 v[64:67], v[32:35], v[48:51], 0
    v_mfma_f32_16x16x32_bf16 v[64:67], v[40:43], v[56:59], v[64:67]
    v_mfma_f32_16x16x32_bf16 v[68:71], v[32:35], v[52:55], 0
    v_mfma_f32_16x16x32_bf16 v[68:71], v[40:43], v[60:63], v[68:71]
    v_mfma_f32_16x16x32_bf16 v[72:75], v[36:39], v[48:51], 0
    v_mfma_f32_16x16x32_bf16 v[72:75], v[44:47], v[56:59], v[72:75]
    v_mfma_f32_16x16x32_bf16 v[76:79], v[36:39], v[52:55], 0
    v_mfma_f32_16x16x32_bf16 v[76:79], v[44:47], v[60:63], v[76:79]
    v_mul_u32_u24 v24, 84, v16
    v_add_u32 v24, v24, v19
    s_mul_i32 s35, s4, 420
    v_add_u32 v24, s35, v24
    v_lshlrev_b32 v24, 2, v24
    v_add_u32 v24, 22528, v24
    v_cmp_gt_u32 s[36:37], 5, v19
    v_cmp_gt_u32 s[38:39], 16, v1
    s_nop 0
    s_and_b64 s[40:41], s[36:37], s[38:39]
    ds_write_b32 v24, v64 offset:0
    ds_write_b32 v24, v65 offset:84
    ds_write_b32 v24, v66 offset:168
    ds_write_b32 v24, v67 offset:252
    s_mov_b64 exec, s[36:37]
    ds_write_b32 v24, v68 offset:64
    ds_write_b32 v24, v69 offset:148
    ds_write_b32 v24, v70 offset:232
    ds_write_b32 v24, v71 offset:316
    s_mov_b64 exec, -1
    s_mov_b64 exec, s[38:39]
    ds_write_b32 v24, v72 offset:1344
    ds_write_b32 v24, v73 offset:1428
    ds_write_b32 v24, v74 offset:1512
    ds_write_b32 v24, v75 offset:1596
    s_mov_b64 exec, -1
    s_mov_b64 exec, s[40:41]
    ds_write_b32 v24, v76 offset:1408
    ds_write_b32 v24, v77 offset:1492
    ds_write_b32 v24, v78 offset:1576
    ds_write_b32 v24, v79 offset:1660
    s_mov_b64 exec, -1
    s_waitcnt lgkmcnt(0)
    s_barrier
    v_lshlrev_b32 v24, 4, v0
    s_lshl_b32 s35, s5, 3
    s_add_u32 s35, s35, s6
    s_mul_i32 s35, s35, 6720
    s_add_u32 s35, s35, 2621440
    ds_read_b128 v[32:35], v24 offset:22528
    ds_read_b128 v[36:39], v24 offset:26624
    s_waitcnt lgkmcnt(0)
    buffer_store_dwordx4 v[32:35], v24, s[24:27], s35 offen
    v_cmp_gt_u32 vcc, 164, v0
    s_nop 0
    s_and_saveexec_b64 s[36:37], vcc
    s_add_u32 s35, s35, 4096
    buffer_store_dwordx4 v[36:39], v24, s[24:27], s35 offen
    s_endpgm
L_k1_c:
    s_sub_u32 s3, s2, 512
    s_load_dwordx2 s[8:9], s[0:1], 24
    s_load_dwordx2 s[10:11], s[0:1], 72
    s_load_dwordx2 s[12:13], s[0:1], 80
    s_load_dwordx2 s[14:15], s[0:1], 96
    v_lshrrev_b32 v4, 8, v0
    s_nop 0
    v_readfirstlane_b32 s4, v4
    v_and_b32 v0, 255, v0
    v_and_b32 v1, 63, v0
    v_lshrrev_b32 v4, 6, v0
    s_mul_i32 s3, s3, 2
    s_add_u32 s3, s3, s4
    s_mul_i32 s5, s4, 9216
    s_waitcnt lgkmcnt(0)
    s_mov_b32 s16, s8
    s_mov_b32 s17, s9
    s_mov_b32 s18, 2621440
    s_mov_b32 s19, 0x00020000
    s_mov_b32 s20, s10
    s_mov_b32 s21, s11
    s_mov_b32 s22, 1280
    s_mov_b32 s23, 0x00020000
    s_mov_b32 s24, s12
    s_mov_b32 s25, s13
    s_mov_b32 s26, 5242880
    s_mov_b32 s27, 0x00020000
    s_mov_b32 s28, s14
    s_mov_b32 s29, s15
    s_mov_b32 s30, 33554432
    s_mov_b32 s31, 0x00020000
L_tru_loop:
    s_mul_i32 s6, s3, 6554
    s_lshr_b32 s6, s6, 16
    s_mul_i32 s7, s6, 10
    s_sub_u32 s7, s3, s7
    v_lshrrev_b32 v5, 3, v0
    v_and_b32 v6, 7, v0
    v_mul_u32_u24 v7, 1280, v5
    v_lshl_add_u32 v7, v6, 4, v7
    s_mul_i32 s32, s6, 81920
    s_lshl_b32 s33, s7, 7
    s_add_u32 s32, s32, s33
    s_add_u32 s33, s32, 40960
    buffer_load_dwordx4 v[8:11], v7, s[16:19], s32 offen
    buffer_load_dwordx4 v[12:15], v7, s[16:19], s33 offen
    v_mul_u32_u24 v16, 144, v5
    v_lshl_add_u32 v16, v6, 4, v16
    v_add_u32 v16, s5, v16
    v_lshrrev_b32 v17, 4, v1
    v_bfe_u32 v18, v1, 2, 2
    v_and_b32 v19, 3, v1
    v_and_b32 v20, 15, v1
    v_lshl_add_u32 v21, v17, 3, v18
    v_mul_u32_u24 v21, 144, v21
    v_lshl_add_u32 v21, v19, 3, v21
    v_lshl_add_u32 v21, v4, 5, v21
    v_add_u32 v21, s5, v21
    v_lshl_add_u32 v22, v4, 4, v20
    v_lshlrev_b32 v23, 12, v22
    v_lshl_add_u32 v23, v17, 4, v23
    s_lshl_b32 s34, s7, 18
    s_lshl_b32 s35, s6, 7
    s_add_u32 s34, s34, s35
    s_add_u32 s34, s34, 12582912
    s_waitcnt vmcnt(0)
    ds_write_b128 v16, v[8:11]
    ds_write_b128 v16, v[12:15] offset:4608
    s_waitcnt lgkmcnt(0)
    s_barrier
    ds_read_b64_tr_b16 v[8:9], v21 offset:0
    ds_read_b64_tr_b16 v[10:11], v21 offset:576
    ds_read_b64_tr_b16 v[12:13], v21 offset:4608
    ds_read_b64_tr_b16 v[14:15], v21 offset:5184
    s_waitcnt lgkmcnt(0)
    buffer_store_dwordx4 v[8:11], v23, s[28:31], s34 offen
    buffer_store_dwordx4 v[12:15], v23, s[28:31], s34 offen offset:64
    s_endpgm
L_k1_exit:
    s_endpgm
.globl k2_kernel
.p2align 8
.type k2_kernel,@function
k2_kernel:
    s_cmp_ge_u32 s2, 672
    s_cbranch_scc1 L_k2_exit
    s_cmp_ge_u32 s2, 32
    s_cbranch_scc1 L_k2_b
    s_load_dwordx2 s[8:9], s[0:1], 16
    s_load_dwordx2 s[12:13], s[0:1], 96
    v_and_b32 v1, 63, v0
    v_lshrrev_b32 v4, 6, v0
    s_nop 0
    v_readfirstlane_b32 s4, v4
    s_lshr_b32 s5, s2, 2
    s_and_b32 s6, s2, 3
    s_waitcnt lgkmcnt(0)
    s_mov_b32 s16, s8
    s_mov_b32 s17, s9
    s_mov_b32 s18, 819200
    s_mov_b32 s19, 0x00020000
    s_mov_b32 s24, s12
    s_mov_b32 s25, s13
    s_mov_b32 s26, 16777216
    s_mov_b32 s27, 0x00020000
    s_mul_i32 s29, s5, 6720
    s_mul_i32 s30, s6, 1680
    s_add_u32 s29, s29, s30
    s_add_u32 s29, s29, 2621440
    v_lshlrev_b32 v25, 2, v0
    v_add_u32 v26, 1024, v25
    v_min_u32 v26, 1676, v26
    s_mov_b32 s34, s29
    buffer_load_dword v28, v25, s[24:27], s34 offen
    buffer_load_dword v112, v26, s[24:27], s34 offen
    s_add_u32 s34, s34, 53760
    buffer_load_dword v29, v25, s[24:27], s34 offen
    buffer_load_dword v113, v26, s[24:27], s34 offen
    s_add_u32 s34, s34, 53760
    buffer_load_dword v30, v25, s[24:27], s34 offen
    buffer_load_dword v114, v26, s[24:27], s34 offen
    s_add_u32 s34, s34, 53760
    buffer_load_dword v31, v25, s[24:27], s34 offen
    buffer_load_dword v115, v26, s[24:27], s34 offen
    s_add_u32 s34, s34, 53760
    buffer_load_dword v32, v25, s[24:27], s34 offen
    buffer_load_dword v116, v26, s[24:27], s34 offen
    s_add_u32 s34, s34, 53760
    buffer_load_dword v33, v25, s[24:27], s34 offen
    buffer_load_dword v117, v26, s[24:27], s34 offen
    s_add_u32 s34, s34, 53760
    buffer_load_dword v34, v25, s[24:27], s34 offen
    buffer_load_dword v118, v26, s[24:27], s34 offen
    s_add_u32 s34, s34, 53760
    buffer_load_dword v35, v25, s[24:27], s34 offen
    buffer_load_dword v119, v26, s[24:27], s34 offen
    s_add_u32 s34, s34, 53760
    buffer_load_dword v36, v25, s[24:27], s34 offen
    buffer_load_dword v120, v26, s[24:27], s34 offen
    s_add_u32 s34, s34, 53760
    buffer_load_dword v37, v25, s[24:27], s34 offen
    buffer_load_dword v121, v26, s[24:27], s34 offen
    s_add_u32 s34, s34, 53760
    buffer_load_dword v38, v25, s[24:27], s34 offen
    buffer_load_dword v122, v26, s[24:27], s34 offen
    s_add_u32 s34, s34, 53760
    buffer_load_dword v39, v25, s[24:27], s34 offen
    buffer_load_dword v123, v26, s[24:27], s34 offen
    s_add_u32 s34, s34, 53760
    buffer_load_dword v40, v25, s[24:27], s34 offen
    buffer_load_dword v124, v26, s[24:27], s34 offen
    s_add_u32 s34, s34, 53760
    buffer_load_dword v41, v25, s[24:27], s34 offen
    buffer_load_dword v125, v26, s[24:27], s34 offen
    s_add_u32 s34, s34, 53760
    buffer_load_dword v42, v25, s[24:27], s34 offen
    buffer_load_dword v126, v26, s[24:27], s34 offen
    s_add_u32 s34, s34, 53760
    buffer_load_dword v43, v25, s[24:27], s34 offen
    buffer_load_dword v127, v26, s[24:27], s34 offen
    s_add_u32 s34, s34, 53760
    buffer_load_dword v44, v25, s[24:27], s34 offen
    buffer_load_dword v128, v26, s[24:27], s34 offen
    s_add_u32 s34, s34, 53760
    buffer_load_dword v45, v25, s[24:27], s34 offen
    buffer_load_dword v129, v26, s[24:27], s34 offen
    s_add_u32 s34, s34, 53760
    buffer_load_dword v46, v25, s[24:27], s34 offen
    buffer_load_dword v130, v26, s[24:27], s34 offen
    s_add_u32 s34, s34, 53760
    buffer_load_dword v47, v25, s[24:27], s34 offen
    buffer_load_dword v131, v26, s[24:27], s34 offen
    s_add_u32 s34, s34, 53760
    buffer_load_dword v48, v25, s[24:27], s34 offen
    buffer_load_dword v132, v26, s[24:27], s34 offen
    s_add_u32 s34, s34, 53760
    buffer_load_dword v49, v25, s[24:27], s34 offen
    buffer_load_dword v133, v26, s[24:27], s34 offen
    s_add_u32 s34, s34, 53760
    buffer_load_dword v50, v25, s[24:27], s34 offen
    buffer_load_dword v134, v26, s[24:27], s34 offen
    s_add_u32 s34, s34, 53760
    buffer_load_dword v51, v25, s[24:27], s34 offen
    buffer_load_dword v135, v26, s[24:27], s34 offen
    s_add_u32 s34, s34, 53760
    buffer_load_dword v52, v25, s[24:27], s34 offen
    buffer_load_dword v136, v26, s[24:27], s34 offen
    s_add_u32 s34, s34, 53760
    buffer_load_dword v53, v25, s[24:27], s34 offen
    buffer_load_dword v137, v26, s[24:27], s34 offen
    s_add_u32 s34, s34, 53760
    buffer_load_dword v54, v25, s[24:27], s34 offen
    buffer_load_dword v138, v26, s[24:27], s34 offen
    s_add_u32 s34, s34, 53760
    buffer_load_dword v55, v25, s[24:27], s34 offen
    buffer_load_dword v139, v26, s[24:27], s34 offen
    s_add_u32 s34, s34, 53760
    buffer_load_dword v56, v25, s[24:27], s34 offen
    buffer_load_dword v140, v26, s[24:27], s34 offen
    s_add_u32 s34, s34, 53760
    buffer_load_dword v57, v25, s[24:27], s34 offen
    buffer_load_dword v141, v26, s[24:27], s34 offen
    s_add_u32 s34, s34, 53760
    buffer_load_dword v58, v25, s[24:27], s34 offen
    buffer_load_dword v142, v26, s[24:27], s34 offen
    s_add_u32 s34, s34, 53760
    buffer_load_dword v59, v25, s[24:27], s34 offen
    buffer_load_dword v143, v26, s[24:27], s34 offen
    s_add_u32 s34, s34, 53760
    s_mul_i32 s28, s2, 25600
    v_add_u32 v16, 0, v0
    v_mul_u32_u24 v17, 52429, v16
    v_lshrrev_b32 v17, 22, v17
    v_mul_u32_u24 v18, 80, v17
    v_sub_u32 v18, v16, v18
    v_mul_u32_u24 v19, 1280, v17
    v_lshl_add_u32 v19, v18, 4, v19
    v_cmp_gt_u32 vcc, 20, v17
    s_nop 1
    v_cndmask_b32 v19, -1, v19, vcc
    v_mul_u32_u24 v8, 1312, v17
    v_lshl_add_u32 v8, v18, 4, v8
    buffer_load_dwordx4 v[64:67], v19, s[16:19], s28 offen
    v_add_u32 v16, 256, v0
    v_mul_u32_u24 v17, 52429, v16
    v_lshrrev_b32 v17, 22, v17
    v_mul_u32_u24 v18, 80, v17
    v_sub_u32 v18, v16, v18
    v_mul_u32_u24 v19, 1280, v17
    v_lshl_add_u32 v19, v18, 4, v19
    v_cmp_gt_u32 vcc, 20, v17
    s_nop 1
    v_cndmask_b32 v19, -1, v19, vcc
    v_mul_u32_u24 v9, 1312, v17
    v_lshl_add_u32 v9, v18, 4, v9
    buffer_load_dwordx4 v[68:71], v19, s[16:19], s28 offen
    v_add_u32 v16, 512, v0
    v_mul_u32_u24 v17, 52429, v16
    v_lshrrev_b32 v17, 22, v17
    v_mul_u32_u24 v18, 80, v17
    v_sub_u32 v18, v16, v18
    v_mul_u32_u24 v19, 1280, v17
    v_lshl_add_u32 v19, v18, 4, v19
    v_cmp_gt_u32 vcc, 20, v17
    s_nop 1
    v_cndmask_b32 v19, -1, v19, vcc
    v_mul_u32_u24 v10, 1312, v17
    v_lshl_add_u32 v10, v18, 4, v10
    buffer_load_dwordx4 v[72:75], v19, s[16:19], s28 offen
    v_add_u32 v16, 768, v0
    v_mul_u32_u24 v17, 52429, v16
    v_lshrrev_b32 v17, 22, v17
    v_mul_u32_u24 v18, 80, v17
    v_sub_u32 v18, v16, v18
    v_mul_u32_u24 v19, 1280, v17
    v_lshl_add_u32 v19, v18, 4, v19
    v_cmp_gt_u32 vcc, 20, v17
    s_nop 1
    v_cndmask_b32 v19, -1, v19, vcc
    v_mul_u32_u24 v11, 1312, v17
    v_lshl_add_u32 v11, v18, 4, v11
    buffer_load_dwordx4 v[76:79], v19, s[16:19], s28 offen
    v_add_u32 v16, 1024, v0
    v_mul_u32_u24 v17, 52429, v16
    v_lshrrev_b32 v17, 22, v17
    v_mul_u32_u24 v18, 80, v17
    v_sub_u32 v18, v16, v18
    v_mul_u32_u24 v19, 1280, v17
    v_lshl_add_u32 v19, v18, 4, v19
    v_cmp_gt_u32 vcc, 20, v17
    s_nop 1
    v_cndmask_b32 v19, -1, v19, vcc
    v_mul_u32_u24 v12, 1312, v17
    v_lshl_add_u32 v12, v18, 4, v12
    buffer_load_dwordx4 v[80:83], v19, s[16:19], s28 offen
    v_add_u32 v16, 1280, v0
    v_mul_u32_u24 v17, 52429, v16
    v_lshrrev_b32 v17, 22, v17
    v_mul_u32_u24 v18, 80, v17
    v_sub_u32 v18, v16, v18
    v_mul_u32_u24 v19, 1280, v17
    v_lshl_add_u32 v19, v18, 4, v19
    v_cmp_gt_u32 vcc, 20, v17
    s_nop 1
    v_cndmask_b32 v19, -1, v19, vcc
    v_mul_u32_u24 v13, 1312, v17
    v_lshl_add_u32 v13, v18, 4, v13
    buffer_load_dwordx4 v[84:87], v19, s[16:19], s28 offen
    v_add_u32 v16, 1536, v0
    v_mul_u32_u24 v17, 52429, v16
    v_lshrrev_b32 v17, 22, v17
    v_mul_u32_u24 v18, 80, v17
    v_sub_u32 v18, v16, v18
    v_mul_u32_u24 v19, 1280, v17
    v_lshl_add_u32 v19, v18, 4, v19
    v_cmp_gt_u32 vcc, 20, v17
    s_nop 1
    v_cndmask_b32 v19, -1, v19, vcc
    v_mul_u32_u24 v14, 1312, v17
    v_lshl_add_u32 v14, v18, 4, v14
    buffer_load_dwordx4 v[88:91], v19, s[16:19], s28 offen
    v_add_u32 v16, 1792, v0
    v_mul_u32_u24 v17, 52429, v16
    v_lshrrev_b32 v17, 22, v17
    v_mul_u32_u24 v18, 80, v17
    v_sub_u32 v18, v16, v18
    v_mul_u32_u24 v19, 1280, v17
    v_lshl_add_u32 v19, v18, 4, v19
    v_cmp_gt_u32 vcc, 20, v17
    s_nop 1
    v_cndmask_b32 v19, -1, v19, vcc
    v_mul_u32_u24 v15, 1312, v17
    v_lshl_add_u32 v15, v18, 4, v15
    buffer_load_dwordx4 v[92:95], v19, s[16:19], s28 offen
    v_add_u32 v16, 2048, v0
    v_mul_u32_u24 v17, 52429, v16
    v_lshrrev_b32 v17, 22, v17
    v_mul_u32_u24 v18, 80, v17
    v_sub_u32 v18, v16, v18
    v_mul_u32_u24 v19, 1280, v17
    v_lshl_add_u32 v19, v18, 4, v19
    v_cmp_gt_u32 vcc, 20, v17
    s_nop 1
    v_cndmask_b32 v19, -1, v19, vcc
    v_mul_u32_u24 v60, 1312, v17
    v_lshl_add_u32 v60, v18, 4, v60
    buffer_load_dwordx4 v[96:99], v19, s[16:19], s28 offen
    v_add_u32 v16, 2304, v0
    v_mul_u32_u24 v17, 52429, v16
    v_lshrrev_b32 v17, 22, v17
    v_mul_u32_u24 v18, 80, v17
    v_sub_u32 v18, v16, v18
    v_mul_u32_u24 v19, 1280, v17
    v_lshl_add_u32 v19, v18, 4, v19
    v_cmp_gt_u32 vcc, 20, v17
    s_nop 1
    v_cndmask_b32 v19, -1, v19, vcc
    v_mul_u32_u24 v61, 1312, v17
    v_lshl_add_u32 v61, v18, 4, v61
    buffer_load_dwordx4 v[100:103], v19, s[16:19], s28 offen
    v_mov_b32 v20, 0
    v_mov_b32 v21, 0
    v_mov_b32 v22, 0
    v_mov_b32 v23, 0
    v_lshlrev_b32 v24, 4, v0
    v_cmp_gt_u32 vcc, 160, v0
    s_nop 0
    s_and_saveexec_b64 s[30:31], vcc
    ds_write_b128 v24, v[20:23] offset:41984
    s_mov_b64 exec, s[30:31]
    s_waitcnt lgkmcnt(0)
    s_barrier
    s_waitcnt vmcnt(10)
    v_add_f32 v28, v28, v44
    v_add_f32 v29, v29, v45
    v_add_f32 v30, v30, v46
    v_add_f32 v31, v31, v47
    v_add_f32 v32, v32, v48
    v_add_f32 v33, v33, v49
    v_add_f32 v34, v34, v50
    v_add_f32 v35, v35, v51
    v_add_f32 v36, v36, v52
    v_add_f32 v37, v37, v53
    v_add_f32 v38, v38, v54
    v_add_f32 v39, v39, v55
    v_add_f32 v40, v40, v56
    v_add_f32 v41, v41, v57
    v_add_f32 v42, v42, v58
    v_add_f32 v43, v43, v59
    v_add_f32 v28, v28, v36
    v_add_f32 v29, v29, v37
    v_add_f32 v30, v30, v38
    v_add_f32 v31, v31, v39
    v_add_f32 v32, v32, v40
    v_add_f32 v33, v33, v41
    v_add_f32 v34, v34, v42
    v_add_f32 v35, v35, v43
    v_add_f32 v28, v28, v32
    v_add_f32 v29, v29, v33
    v_add_f32 v30, v30, v34
    v_add_f32 v31, v31, v35
    v_add_f32 v28, v28, v30
    v_add_f32 v29, v29, v31
    v_add_f32 v28, v28, v29
    v_add_u32 v16, 0, v0
    v_mul_u32_u24 v17, 49933, v16
    v_lshrrev_b32 v17, 20, v17
    v_mul_u32_u24 v18, 21, v17
    v_sub_u32 v18, v16, v18
    v_cmp_eq_u32 s[32:33], 20, v18
    v_cvt_pk_bf16_f32 v27, v28, v28
    v_mul_u32_u24 v26, 80, v17
    v_lshl_add_u32 v26, v18, 1, v26
    s_mov_b64 s[36:37], exec
    s_andn2_b64 exec, exec, s[32:33]
    ds_write_b16 v26, v27 offset:41984
    s_and_b64 exec, s[36:37], s[32:33]
    s_mul_i32 s35, s2, 40
    s_add_u32 s35, s35, 11534336
    v_lshlrev_b32 v26, 1, v17
    buffer_store_short v27, v26, s[24:27], s35 offen
    s_mov_b64 exec, -1
    v_add_f32 v112, v112, v128
    v_add_f32 v113, v113, v129
    v_add_f32 v114, v114, v130
    v_add_f32 v115, v115, v131
    v_add_f32 v116, v116, v132
    v_add_f32 v117, v117, v133
    v_add_f32 v118, v118, v134
    v_add_f32 v119, v119, v135
    v_add_f32 v120, v120, v136
    v_add_f32 v121, v121, v137
    v_add_f32 v122, v122, v138
    v_add_f32 v123, v123, v139
    v_add_f32 v124, v124, v140
    v_add_f32 v125, v125, v141
    v_add_f32 v126, v126, v142
    v_add_f32 v127, v127, v143
    v_add_f32 v112, v112, v120
    v_add_f32 v113, v113, v121
    v_add_f32 v114, v114, v122
    v_add_f32 v115, v115, v123
    v_add_f32 v116, v116, v124
    v_add_f32 v117, v117, v125
    v_add_f32 v118, v118, v126
    v_add_f32 v119, v119, v127
    v_add_f32 v112, v112, v116
    v_add_f32 v113, v113, v117
    v_add_f32 v114, v114, v118
    v_add_f32 v115, v115, v119
    v_add_f32 v112, v112, v114
    v_add_f32 v113, v113, v115
    v_add_f32 v112, v112, v113
    v_cmp_gt_u32 vcc, 164, v0
    s_nop 0
    s_and_saveexec_b64 s[30:31], vcc
    v_add_u32 v16, 256, v0
    v_mul_u32_u24 v17, 49933, v16
    v_lshrrev_b32 v17, 20, v17
    v_mul_u32_u24 v18, 21, v17
    v_sub_u32 v18, v16, v18
    v_cmp_eq_u32 s[32:33], 20, v18
    v_cvt_pk_bf16_f32 v27, v112, v112
    v_mul_u32_u24 v26, 80, v17
    v_lshl_add_u32 v26, v18, 1, v26
    s_mov_b64 s[36:37], exec
    s_andn2_b64 exec, exec, s[32:33]
    ds_write_b16 v26, v27 offset:41984
    s_and_b64 exec, s[36:37], s[32:33]
    s_mul_i32 s35, s2, 40
    s_add_u32 s35, s35, 11534336
    v_lshlrev_b32 v26, 1, v17
    buffer_store_short v27, v26, s[24:27], s35 offen
    s_mov_b64 exec, -1
    s_waitcnt vmcnt(0)
    ds_write_b128 v8, v[64:67]
    ds_write_b128 v9, v[68:71]
    ds_write_b128 v10, v[72:75]
    ds_write_b128 v11, v[76:79]
    ds_write_b128 v12, v[80:83]
    ds_write_b128 v13, v[84:87]
    ds_write_b128 v14, v[88:91]
    ds_write_b128 v15, v[92:95]
    ds_write_b128 v60, v[96:99]
    ds_write_b128 v61, v[100:103]
    s_waitcnt lgkmcnt(0)
    s_barrier
    v_lshrrev_b32 v16, 4, v1
    v_bfe_u32 v17, v1, 2, 2
    v_and_b32 v18, 3, v1
    v_and_b32 v19, 15, v1
    v_mul_u32_u24 v20, 80, v19
    v_lshl_add_u32 v20, v16, 3, v20
    ds_read_b64 v[32:33], v20 offset:41984
    ds_read_b64 v[34:35], v20 offset:42016
    ds_read_b64 v[36:37], v20 offset:43264
    ds_read_b64 v[38:39], v20 offset:43296
    v_lshl_add_u32 v21, v16, 2, v17
    v_mul_u32_u24 v21, 1312, v21
    v_lshl_add_u32 v21, v18, 3, v21
    s_mul_i32 s35, s4, 320
    v_add_u32 v21, s35, v21
    s_mul_i32 s35, s2, 5
    v_add_u32 v24, s35, v16
    v_lshrrev_b32 v25, 3, v24
    v_and_b32 v26, 3, v24
    v_bfe_u32 v27, v24, 2, 1
    v_lshlrev_b32 v22, 10, v25
    v_lshl_add_u32 v22, v26, 8, v22
    v_lshl_add_u32 v22, v19, 4, v22
    v_lshl_add_u32 v22, v27, 3, v22
    v_add_u32 v24, s35, v16
    v_add_u32 v24, 4, v24
    v_lshrrev_b32 v25, 3, v24
    v_and_b32 v26, 3, v24
    v_bfe_u32 v27, v24, 2, 1
    v_lshlrev_b32 v23, 10, v25
    v_lshl_add_u32 v23, v26, 8, v23
    v_lshl_add_u32 v23, v19, 4, v23
    v_lshl_add_u32 v23, v27, 3, v23
    s_mul_i32 s36, s4, 204800
    s_add_u32 s36, s36, 10485760
    v_cmp_gt_u32 s[38:39], 16, v1
    ds_read_b64_tr_b16 v[40:41], v21 offset:0
    ds_read_b64_tr_b16 v[42:43], v21 offset:20992
    ds_read_b64_tr_b16 v[44:45], v21 offset:32
    ds_read_b64_tr_b16 v[46:47], v21 offset:21024
    ds_read_b64_tr_b16 v[48:49], v21 offset:64
    ds_read_b64_tr_b16 v[50:51], v21 offset:21056
    ds_read_b64_tr_b16 v[52:53], v21 offset:96
    ds_read_b64_tr_b16 v[54:55], v21 offset:21088
    ds_read_b64_tr_b16 v[56:57], v21 offset:128
    ds_read_b64_tr_b16 v[58:59], v21 offset:21120
    ds_read_b64_tr_b16 v[60:61], v21 offset:160
    ds_read_b64_tr_b16 v[62:63], v21 offset:21152
    ds_read_b64_tr_b16 v[64:65], v21 offset:192
    ds_read_b64_tr_b16 v[66:67], v21 offset:21184
    ds_read_b64_tr_b16 v[68:69], v21 offset:224
    ds_read_b64_tr_b16 v[70:71], v21 offset:21216
    ds_read_b64_tr_b16 v[72:73], v21 offset:256
    ds_read_b64_tr_b16 v[74:75], v21 offset:21248
    ds_read_b64_tr_b16 v[76:77], v21 offset:288
    ds_read_b64_tr_b16 v[78:79], v21 offset:21280
    s_waitcnt lgkmcnt(15)
    v_mfma_f32_16x16x32_bf16 v[80:83], v[32:35], v[40:43], 0
    v_mfma_f32_16x16x32_bf16 v[84:87], v[36:39], v[40:43], 0
    s_nop 6
    v_cvt_pk_bf16_f32 v96, v80, v81
    v_cvt_pk_bf16_f32 v97, v82, v83
    v_cvt_pk_bf16_f32 v98, v84, v85
    v_cvt_pk_bf16_f32 v99, v86, v87
    s_add_u32 s37, s36, 0
    buffer_store_dwordx2 v[96:97], v22, s[24:27], s37 offen
    s_mov_b64 exec, s[38:39]
    buffer_store_dwordx2 v[98:99], v23, s[24:27], s37 offen
    s_mov_b64 exec, -1
    s_waitcnt lgkmcnt(15)
    v_mfma_f32_16x16x32_bf16 v[88:91], v[32:35], v[44:47], 0
    v_mfma_f32_16x16x32_bf16 v[92:95], v[36:39], v[44:47], 0
    s_nop 6
    v_cvt_pk_bf16_f32 v100, v88, v89
    v_cvt_pk_bf16_f32 v101, v90, v91
    v_cvt_pk_bf16_f32 v102, v92, v93
    v_cvt_pk_bf16_f32 v103, v94, v95
    s_add_u32 s37, s36, 20480
    buffer_store_dwordx2 v[100:101], v22, s[24:27], s37 offen
    s_mov_b64 exec, s[38:39]
    buffer_store_dwordx2 v[102:103], v23, s[24:27], s37 offen
    s_mov_b64 exec, -1
    s_waitcnt lgkmcnt(14)
    v_mfma_f32_16x16x32_bf16 v[80:83], v[32:35], v[48:51], 0
    v_mfma_f32_16x16x32_bf16 v[84:87], v[36:39], v[48:51], 0
    s_nop 6
    v_cvt_pk_bf16_f32 v96, v80, v81
    v_cvt_pk_bf16_f32 v97, v82, v83
    v_cvt_pk_bf16_f32 v98, v84, v85
    v_cvt_pk_bf16_f32 v99, v86, v87
    s_add_u32 s37, s36, 40960
    buffer_store_dwordx2 v[96:97], v22, s[24:27], s37 offen
    s_mov_b64 exec, s[38:39]
    buffer_store_dwordx2 v[98:99], v23, s[24:27], s37 offen
    s_mov_b64 exec, -1
    s_waitcnt lgkmcnt(12)
    v_mfma_f32_16x16x32_bf16 v[88:91], v[32:35], v[52:55], 0
    v_mfma_f32_16x16x32_bf16 v[92:95], v[36:39], v[52:55], 0
    s_nop 6
    v_cvt_pk_bf16_f32 v100, v88, v89
    v_cvt_pk_bf16_f32 v101, v90, v91
    v_cvt_pk_bf16_f32 v102, v92, v93
    v_cvt_pk_bf16_f32 v103, v94, v95
    s_add_u32 s37, s36, 61440
    buffer_store_dwordx2 v[100:101], v22, s[24:27], s37 offen
    s_mov_b64 exec, s[38:39]
    buffer_store_dwordx2 v[102:103], v23, s[24:27], s37 offen
    s_mov_b64 exec, -1
    s_waitcnt lgkmcnt(10)
    v_mfma_f32_16x16x32_bf16 v[80:83], v[32:35], v[56:59], 0
    v_mfma_f32_16x16x32_bf16 v[84:87], v[36:39], v[56:59], 0
    s_nop 6
    v_cvt_pk_bf16_f32 v96, v80, v81
    v_cvt_pk_bf16_f32 v97, v82, v83
    v_cvt_pk_bf16_f32 v98, v84, v85
    v_cvt_pk_bf16_f32 v99, v86, v87
    s_add_u32 s37, s36, 81920
    buffer_store_dwordx2 v[96:97], v22, s[24:27], s37 offen
    s_mov_b64 exec, s[38:39]
    buffer_store_dwordx2 v[98:99], v23, s[24:27], s37 offen
    s_mov_b64 exec, -1
    s_waitcnt lgkmcnt(8)
    v_mfma_f32_16x16x32_bf16 v[88:91], v[32:35], v[60:63], 0
    v_mfma_f32_16x16x32_bf16 v[92:95], v[36:39], v[60:63], 0
    s_nop 6
    v_cvt_pk_bf16_f32 v100, v88, v89
    v_cvt_pk_bf16_f32 v101, v90, v91
    v_cvt_pk_bf16_f32 v102, v92, v93
    v_cvt_pk_bf16_f32 v103, v94, v95
    s_add_u32 s37, s36, 102400
    buffer_store_dwordx2 v[100:101], v22, s[24:27], s37 offen
    s_mov_b64 exec, s[38:39]
    buffer_store_dwordx2 v[102:103], v23, s[24:27], s37 offen
    s_mov_b64 exec, -1
    s_waitcnt lgkmcnt(6)
    v_mfma_f32_16x16x32_bf16 v[80:83], v[32:35], v[64:67], 0
    v_mfma_f32_16x16x32_bf16 v[84:87], v[36:39], v[64:67], 0
    s_nop 6
    v_cvt_pk_bf16_f32 v96, v80, v81
    v_cvt_pk_bf16_f32 v97, v82, v83
    v_cvt_pk_bf16_f32 v98, v84, v85
    v_cvt_pk_bf16_f32 v99, v86, v87
    s_add_u32 s37, s36, 122880
    buffer_store_dwordx2 v[96:97], v22, s[24:27], s37 offen
    s_mov_b64 exec, s[38:39]
    buffer_store_dwordx2 v[98:99], v23, s[24:27], s37 offen
    s_mov_b64 exec, -1
    s_waitcnt lgkmcnt(4)
    v_mfma_f32_16x16x32_bf16 v[88:91], v[32:35], v[68:71], 0
    v_mfma_f32_16x16x32_bf16 v[92:95], v[36:39], v[68:71], 0
    s_nop 6
    v_cvt_pk_bf16_f32 v100, v88, v89
    v_cvt_pk_bf16_f32 v101, v90, v91
    v_cvt_pk_bf16_f32 v102, v92, v93
    v_cvt_pk_bf16_f32 v103, v94, v95
    s_add_u32 s37, s36, 143360
    buffer_store_dwordx2 v[100:101], v22, s[24:27], s37 offen
    s_mov_b64 exec, s[38:39]
    buffer_store_dwordx2 v[102:103], v23, s[24:27], s37 offen
    s_mov_b64 exec, -1
    s_waitcnt lgkmcnt(2)
    v_mfma_f32_16x16x32_bf16 v[80:83], v[32:35], v[72:75], 0
    v_mfma_f32_16x16x32_bf16 v[84:87], v[36:39], v[72:75], 0
    s_nop 6
    v_cvt_pk_bf16_f32 v96, v80, v81
    v_cvt_pk_bf16_f32 v97, v82, v83
    v_cvt_pk_bf16_f32 v98, v84, v85
    v_cvt_pk_bf16_f32 v99, v86, v87
    s_add_u32 s37, s36, 163840
    buffer_store_dwordx2 v[96:97], v22, s[24:27], s37 offen
    s_mov_b64 exec, s[38:39]
    buffer_store_dwordx2 v[98:99], v23, s[24:27], s37 offen
    s_mov_b64 exec, -1
    s_waitcnt lgkmcnt(0)
    v_mfma_f32_16x16x32_bf16 v[88:91], v[32:35], v[76:79], 0
    v_mfma_f32_16x16x32_bf16 v[92:95], v[36:39], v[76:79], 0
    s_nop 6
    v_cvt_pk_bf16_f32 v100, v88, v89
    v_cvt_pk_bf16_f32 v101, v90, v91
    v_cvt_pk_bf16_f32 v102, v92, v93
    v_cvt_pk_bf16_f32 v103, v94, v95
    s_add_u32 s37, s36, 184320
    buffer_store_dwordx2 v[100:101], v22, s[24:27], s37 offen
    s_mov_b64 exec, s[38:39]
    buffer_store_dwordx2 v[102:103], v23, s[24:27], s37 offen
    s_mov_b64 exec, -1
    s_endpgm
L_k2_b:
    s_sub_u32 s3, s2, 32
    s_load_dwordx2 s[14:15], s[0:1], 96
    v_and_b32 v1, 63, v0
    v_lshrrev_b32 v4, 6, v0
    s_nop 0
    v_readfirstlane_b32 s4, v4
    v_lshlrev_b32 v6, 4, v0
    s_mul_i32 s34, s3, 4416
    s_add_u32 s34, s34, 7340024
    s_add_u32 s40, s34, 4096
    s_lshl_b32 s32, s3, 12
    s_add_u32 s33, s32, 12582912
    s_waitcnt lgkmcnt(0)
    s_mov_b32 s28, s14
    s_mov_b32 s29, s15
    s_mov_b32 s30, 33554432
    s_mov_b32 s31, 0x00020000
    buffer_load_dwordx4 v[8:11], v6, s[28:31], s33 offen
    buffer_load_dwordx2 v[24:25], v6, s[28:31], s34 offen
    buffer_load_dwordx4 v[26:29], v6, s[28:31], s34 offen offset:8
    buffer_load_dwordx2 v[30:31], v6, s[28:31], s40 offen
    buffer_load_dwordx4 v[32:35], v6, s[28:31], s40 offen offset:8
    v_mov_b32 v60, 0
    v_mov_b32 v61, 0
    v_mov_b32 v62, 0
    v_mov_b32 v63, 0
    v_cmp_gt_u32 vcc, 160, v0
    s_nop 0
    s_and_saveexec_b64 s[36:37], vcc
    ds_write_b128 v6, v[60:63] offset:17664
    s_mov_b64 exec, s[36:37]
    v_lshrrev_b32 v7, 2, v0
    v_mul_u32_u24 v7, 80, v7
    v_and_b32 v12, 3, v0
    v_lshl_add_u32 v7, v12, 4, v7
    s_waitcnt vmcnt(4)
    ds_write_b128 v7, v[8:11] offset:20224
    s_waitcnt vmcnt(2)
    v_cmp_eq_u32 vcc, 0, v0
    s_nop 1
    v_cndmask_b32 v24, v24, 0, vcc
    v_cndmask_b32 v25, v25, 0, vcc
    ds_write_b128 v6, v[26:29] offset:0
    v_alignbit_b32 v64, v26, v25, 16
    v_alignbit_b32 v65, v27, v26, 16
    v_alignbit_b32 v66, v28, v27, 16
    v_alignbit_b32 v67, v29, v28, 16
    ds_write_b128 v6, v[64:67] offset:4416
    v_mov_b32 v68, v25
    v_mov_b32 v69, v26
    v_mov_b32 v70, v27
    v_mov_b32 v71, v28
    ds_write_b128 v6, v[68:71] offset:8832
    v_alignbit_b32 v72, v25, v24, 16
    v_alignbit_b32 v73, v26, v25, 16
    v_alignbit_b32 v74, v27, v26, 16
    v_alignbit_b32 v75, v28, v27, 16
    ds_write_b128 v6, v[72:75] offset:13248
    s_waitcnt vmcnt(0)
    v_cmp_gt_u32 vcc, 20, v0
    s_nop 0
    s_and_saveexec_b64 s[36:37], vcc
    ds_write_b128 v6, v[32:35] offset:4096
    v_alignbit_b32 v64, v32, v31, 16
    v_alignbit_b32 v65, v33, v32, 16
    v_alignbit_b32 v66, v34, v33, 16
    v_alignbit_b32 v67, v35, v34, 16
    ds_write_b128 v6, v[64:67] offset:8512
    v_mov_b32 v68, v31
    v_mov_b32 v69, v32
    v_mov_b32 v70, v33
    v_mov_b32 v71, v34
    ds_write_b128 v6, v[68:71] offset:12928
    v_alignbit_b32 v72, v31, v30, 16
    v_alignbit_b32 v73, v32, v31, 16
    v_alignbit_b32 v74, v33, v32, 16
    v_alignbit_b32 v75, v34, v33, 16
    ds_write_b128 v6, v[72:75] offset:17344
    s_mov_b64 exec, s[36:37]
    v_and_b32 v8, 31, v1
    v_lshrrev_b32 v9, 5, v1
    v_and_b32 v10, 3, v8
    v_mul_u32_u24 v10, 4416, v10
    v_and_b32 v11, 28, v8
    v_sub_u32 v11, 32, v11
    v_lshl_add_u32 v11, v9, 3, v11
    v_lshl_add_u32 v10, v11, 1, v10
    s_and_b32 s5, s4, 1
    s_lshr_b32 s6, s4, 1
    s_lshl_b32 s6, s6, 5
    s_xor_b32 s5, s5, 1
    s_lshl_b32 s7, s5, 6
    s_add_u32 s7, s7, s6
    v_add_u32 v10, s7, v10
    v_mul_u32_u24 v11, 80, v8
    v_lshl_add_u32 v11, v9, 4, v11
    s_mul_i32 s7, s5, 80
    s_add_u32 s7, s7, s6
    s_add_u32 s7, s7, 17744
    v_add_u32 v11, s7, v11
    v_mov_b32 v64, 0
    v_mov_b32 v65, 0
    v_mov_b32 v66, 0
    v_mov_b32 v67, 0
    v_mov_b32 v68, 0
    v_mov_b32 v69, 0
    v_mov_b32 v70, 0
    v_mov_b32 v71, 0
    v_mov_b32 v72, 0
    v_mov_b32 v73, 0
    v_mov_b32 v74, 0
    v_mov_b32 v75, 0
    v_mov_b32 v76, 0
    v_mov_b32 v77, 0
    v_mov_b32 v78, 0
    v_mov_b32 v79, 0
    v_mov_b32 v80, 0
    v_mov_b32 v81, 0
    v_mov_b32 v82, 0
    v_mov_b32 v83, 0
    v_mov_b32 v84, 0
    v_mov_b32 v85, 0
    v_mov_b32 v86, 0
    v_mov_b32 v87, 0
    v_mov_b32 v88, 0
    v_mov_b32 v89, 0
    v_mov_b32 v90, 0
    v_mov_b32 v91, 0
    v_mov_b32 v92, 0
    v_mov_b32 v93, 0
    v_mov_b32 v94, 0
    v_mov_b32 v95, 0
    s_waitcnt lgkmcnt(0)
    s_barrier
    v_add_u32 v10, 1792, v10
    v_add_u32 v11, 2240, v11
    ds_read_b64 v[96:97], v10 offset:2176
    ds_read_b64 v[98:99], v10 offset:2184
    ds_read_b128 v[104:107], v11 offset:160
    ds_read_b128 v[108:111], v11 offset:2720
    ds_read_b64 v[100:101], v10 offset:128
    ds_read_b64 v[102:103], v10 offset:136
    s_mov_b32 s5, 0
L_cv_ml:
    ds_read_b64 v[112:113], v10 offset:2048
    ds_read_b64 v[114:115], v10 offset:2056
    ds_read_b128 v[120:123], v11 offset:0
    ds_read_b128 v[124:127], v11 offset:2560
    ds_read_b64 v[116:117], v10 offset:0
    ds_read_b64 v[118:119], v10 offset:8
    s_waitcnt lgkmcnt(6)
    v_mfma_f32_32x32x16_bf16 v[64:79], v[96:99], v[104:107], v[64:79]
    v_mfma_f32_32x32x16_bf16 v[80:95], v[96:99], v[108:111], v[80:95]
    v_mfma_f32_32x32x16_bf16 v[80:95], v[100:103], v[104:107], v[80:95]
    s_add_u32 s5, s5, 1
    s_cmp_ge_u32 s5, 8
    s_cbranch_scc1 L_cv_mlend
    v_subrev_u32 v10, 256, v10
    v_subrev_u32 v11, 320, v11
    ds_read_b64 v[96:97], v10 offset:2176
    ds_read_b64 v[98:99], v10 offset:2184
    ds_read_b128 v[104:107], v11 offset:160
    ds_read_b128 v[108:111], v11 offset:2720
    ds_read_b64 v[100:101], v10 offset:128
    ds_read_b64 v[102:103], v10 offset:136
    s_waitcnt lgkmcnt(6)
    v_mfma_f32_32x32x16_bf16 v[64:79], v[112:115], v[120:123], v[64:79]
    v_mfma_f32_32x32x16_bf16 v[80:95], v[112:115], v[124:127], v[80:95]
    v_mfma_f32_32x32x16_bf16 v[80:95], v[116:119], v[120:123], v[80:95]
    s_branch L_cv_ml
L_cv_mlend:
    s_waitcnt lgkmcnt(0)
    v_mfma_f32_32x32x16_bf16 v[64:79], v[112:115], v[120:123], v[64:79]
    v_mfma_f32_32x32x16_bf16 v[80:95], v[112:115], v[124:127], v[80:95]
    v_mfma_f32_32x32x16_bf16 v[80:95], v[116:119], v[120:123], v[80:95]
    s_nop 15
    s_barrier
    v_lshlrev_b32 v12, 4, v1
    s_cmp_eq_u32 s4, 0
    s_cbranch_scc0 L_cv_w0
    ds_write_b128 v12, v[72:75] offset:6144
    ds_write_b128 v12, v[76:79] offset:7168
    ds_write_b128 v12, v[80:83] offset:12288
    ds_write_b128 v12, v[84:87] offset:13312
    ds_write_b128 v12, v[88:91] offset:18432
    ds_write_b128 v12, v[92:95] offset:19456
    v_mov_b32 v96, v64
    v_mov_b32 v97, v65
    v_mov_b32 v98, v66
    v_mov_b32 v99, v67
    v_mov_b32 v100, v68
    v_mov_b32 v101, v69
    v_mov_b32 v102, v70
    v_mov_b32 v103, v71
L_cv_w0:
    s_cmp_eq_u32 s4, 1
    s_cbranch_scc0 L_cv_w1
    ds_write_b128 v12, v[64:67] offset:0
    ds_write_b128 v12, v[68:71] offset:1024
    ds_write_b128 v12, v[80:83] offset:14336
    ds_write_b128 v12, v[84:87] offset:15360
    ds_write_b128 v12, v[88:91] offset:20480
    ds_write_b128 v12, v[92:95] offset:21504
    v_mov_b32 v96, v72
    v_mov_b32 v97, v73
    v_mov_b32 v98, v74
    v_mov_b32 v99, v75
    v_mov_b32 v100, v76
    v_mov_b32 v101, v77
    v_mov_b32 v102, v78
    v_mov_b32 v103, v79
L_cv_w1:
    s_cmp_eq_u32 s4, 2
    s_cbranch_scc0 L_cv_w2
    ds_write_b128 v12, v[64:67] offset:2048
    ds_write_b128 v12, v[68:71] offset:3072
    ds_write_b128 v12, v[72:75] offset:8192
    ds_write_b128 v12, v[76:79] offset:9216
    ds_write_b128 v12, v[88:91] offset:22528
    ds_write_b128 v12, v[92:95] offset:23552
    v_mov_b32 v96, v80
    v_mov_b32 v97, v81
    v_mov_b32 v98, v82
    v_mov_b32 v99, v83
    v_mov_b32 v100, v84
    v_mov_b32 v101, v85
    v_mov_b32 v102, v86
    v_mov_b32 v103, v87
L_cv_w2:
    s_cmp_eq_u32 s4, 3
    s_cbranch_scc0 L_cv_w3
    ds_write_b128 v12, v[64:67] offset:4096
    ds_write_b128 v12, v[68:71] offset:5120
    ds_write_b128 v12, v[72:75] offset:10240
    ds_write_b128 v12, v[76:79] offset:11264
    ds_write_b128 v12, v[80:83] offset:16384
    ds_write_b128 v12, v[84:87] offset:17408
    v_mov_b32 v96, v88
    v_mov_b32 v97, v89
    v_mov_b32 v98, v90
    v_mov_b32 v99, v91
    v_mov_b32 v100, v92
    v_mov_b32 v101, v93
    v_mov_b32 v102, v94
    v_mov_b32 v103, v95
L_cv_w3:
    s_waitcnt lgkmcnt(0)
    s_barrier
    s_mul_i32 s5, s4, 6144
    v_add_u32 v13, s5, v12
    ds_read_b128 v[104:107], v13 offset:0
    ds_read_b128 v[108:111], v13 offset:1024
    ds_read_b128 v[112:115], v13 offset:2048
    ds_read_b128 v[116:119], v13 offset:3072
    ds_read_b128 v[120:123], v13 offset:4096
    ds_read_b128 v[124:127], v13 offset:5120
    s_waitcnt lgkmcnt(0)
    v_add_f32 v104, v104, v112
    v_add_f32 v96, v96, v120
    v_add_f32 v96, v96, v104
    v_add_f32 v105, v105, v113
    v_add_f32 v97, v97, v121
    v_add_f32 v97, v97, v105
    v_add_f32 v106, v106, v114
    v_add_f32 v98, v98, v122
    v_add_f32 v98, v98, v106
    v_add_f32 v107, v107, v115
    v_add_f32 v99, v99, v123
    v_add_f32 v99, v99, v107
    v_add_f32 v108, v108, v116
    v_add_f32 v100, v100, v124
    v_add_f32 v100, v100, v108
    v_add_f32 v109, v109, v117
    v_add_f32 v101, v101, v125
    v_add_f32 v101, v101, v109
    v_add_f32 v110, v110, v118
    v_add_f32 v102, v102, v126
    v_add_f32 v102, v102, v110
    v_add_f32 v111, v111, v119
    v_add_f32 v103, v103, v127
    v_add_f32 v103, v103, v111
    v_lshlrev_b32 v12, 6, v8
    v_lshl_add_u32 v12, v9, 3, v12
    s_lshr_b32 s5, s4, 1
    s_lshl_b32 s5, s5, 11
    s_and_b32 s6, s4, 1
    s_lshl_b32 s6, s6, 5
    s_add_u32 s5, s5, s6
    v_add_u32 v12, s5, v12
    v_cvt_pk_bf16_f32 v104, v96, v97
    v_cvt_pk_bf16_f32 v105, v98, v99
    ds_write_b64 v12, v[104:105] offset:24576
    v_cvt_pk_bf16_f32 v106, v100, v101
    v_cvt_pk_bf16_f32 v107, v102, v103
    ds_write_b64 v12, v[106:107] offset:24592
    s_waitcnt lgkmcnt(0)
    s_barrier
    ds_read_b128 v[96:99], v6 offset:24576
    s_add_u32 s33, s32, 15728640
    s_waitcnt lgkmcnt(0)
    buffer_store_dwordx4 v[96:99], v6, s[28:31], s33 offen
    s_endpgm
L_k2_exit:
    s_endpgm
.globl k3_kernel
.p2align 8
.type k3_kernel,@function
k3_kernel:
    s_cmp_ge_u32 s2, 240
    s_cbranch_scc1 L_k3_exit
    s_cmp_ge_u32 s2, 160
    s_cbranch_scc1 L_k3_b
    s_load_dwordx2 s[8:9], s[0:1], 80
    s_load_dwordx2 s[12:13], s[0:1], 96
    v_and_b32 v1, 63, v0
    v_lshrrev_b32 v4, 6, v0
    s_nop 0
    v_readfirstlane_b32 s4, v4
    s_lshr_b32 s7, s2, 3
    s_mul_i32 s5, s7, 52429
    s_lshr_b32 s5, s5, 18
    s_mul_i32 s6, s5, 5
    s_sub_u32 s6, s7, s6
    s_and_b32 s7, s2, 7
    s_lshl_b32 s7, s7, 2
    s_add_u32 s5, s5, s7
    v_lshlrev_b32 v5, 4, v1
    s_waitcnt lgkmcnt(0)
    s_mov_b32 s16, s8
    s_mov_b32 s17, s9
    s_mov_b32 s18, 5242880
    s_mov_b32 s19, 0x00020000
    s_mov_b32 s24, s12
    s_mov_b32 s25, s13
    s_mov_b32 s26, 16777216
    s_mov_b32 s27, 0x00020000
    s_mul_i32 s30, s4, 160
    s_add_u32 m0, s30, 81920
    s_add_u32 s30, s30, 11534336
    v_cmp_gt_u32 vcc, 10, v1
    s_nop 0
    s_and_saveexec_b64 s[32:33], vcc
    buffer_load_dwordx4 v5, s[24:27], s30 offen lds
    s_mov_b64 exec, s[32:33]
    s_mul_i32 s28, s5, 81920
    s_mul_i32 s29, s4, 10240
    s_add_u32 s28, s28, s29
    s_add_u32 m0, s29, 0
    s_add_u32 s30, s28, 0
    buffer_load_dwordx4 v5, s[24:27], s30 offen lds
    s_add_u32 m0, s29, 1024
    s_add_u32 s30, s28, 1024
    buffer_load_dwordx4 v5, s[24:27], s30 offen lds
    s_add_u32 m0, s29, 2048
    s_add_u32 s30, s28, 2048
    buffer_load_dwordx4 v5, s[24:27], s30 offen lds
    s_add_u32 m0, s29, 3072
    s_add_u32 s30, s28, 3072
    buffer_load_dwordx4 v5, s[24:27], s30 offen lds
    s_add_u32 m0, s29, 4096
    s_add_u32 s30, s28, 4096
    buffer_load_dwordx4 v5, s[24:27], s30 offen lds
    s_add_u32 m0, s29, 5120
    s_add_u32 s30, s28, 5120
    buffer_load_dwordx4 v5, s[24:27], s30 offen lds
    s_add_u32 m0, s29, 6144
    s_add_u32 s30, s28, 6144
    buffer_load_dwordx4 v5, s[24:27], s30 offen lds
    s_add_u32 m0, s29, 7168
    s_add_u32 s30, s28, 7168
    buffer_load_dwordx4 v5, s[24:27], s30 offen lds
    s_add_u32 m0, s29, 8192
    s_add_u32 s30, s28, 8192
    buffer_load_dwordx4 v5, s[24:27], s30 offen lds
    s_add_u32 m0, s29, 9216
    s_add_u32 s30, s28, 9216
    buffer_load_dwordx4 v5, s[24:27], s30 offen lds
    s_lshl_b32 s29, s6, 3
    s_add_u32 s29, s29, s4
    s_mul_i32 s34, s29, 20480
    s_add_u32 s34, s34, 10485760
    s_mov_b32 s61, 0xffff0000
    s_mov_b32 s62, 0x358637bd
    v_lshrrev_b32 v6, 4, v1
    v_mul_u32_u24 v6, 20480, v6
    v_and_b32 v7, 15, v1
    v_lshl_add_u32 v6, v7, 3, v6
    s_mul_i32 s30, s4, 2560
    v_add_u32 v6, s30, v6
    s_mul_i32 s30, s4, 160
    s_add_u32 s30, s30, 81920
    v_mov_b32 v7, s30
    s_waitcnt vmcnt(0)
    s_barrier
    ds_read_b64 v[120:121], v6 offset:0
    ds_read_b64 v[140:141], v7 offset:0
    ds_read_b64 v[122:123], v6 offset:128
    ds_read_b64 v[142:143], v7 offset:8
    ds_read_b64 v[124:125], v6 offset:256
    ds_read_b64 v[144:145], v7 offset:16
    ds_read_b64 v[126:127], v6 offset:384
    ds_read_b64 v[146:147], v7 offset:24
    ds_read_b64 v[128:129], v6 offset:512
    ds_read_b64 v[148:149], v7 offset:32
    ds_read_b64 v[130:131], v6 offset:640
    ds_read_b64 v[150:151], v7 offset:40
    ds_read_b64 v[132:133], v6 offset:768
    ds_read_b64 v[152:153], v7 offset:48
    ds_read_b64 v[134:135], v6 offset:896
    ds_read_b64 v[154:155], v7 offset:56
    ds_read_b64 v[136:137], v6 offset:1024
    ds_read_b64 v[156:157], v7 offset:64
    ds_read_b64 v[138:139], v6 offset:1152
    ds_read_b64 v[158:159], v7 offset:72
    s_waitcnt lgkmcnt(10)
    v_dot2_f32_bf16 v32, v120, v140, 0
    v_dot2_f32_bf16 v33, v121, v141, 0
    v_dot2_f32_bf16 v32, v122, v142, v32
    v_dot2_f32_bf16 v33, v123, v143, v33
    v_dot2_f32_bf16 v32, v124, v144, v32
    v_dot2_f32_bf16 v33, v125, v145, v33
    v_dot2_f32_bf16 v32, v126, v146, v32
    v_dot2_f32_bf16 v33, v127, v147, v33
    v_dot2_f32_bf16 v32, v128, v148, v32
    v_dot2_f32_bf16 v33, v129, v149, v33
    buffer_load_dwordx4 v[40:43], v5, s[24:27], s34 offen offset:0
    v_lshlrev_b32 v8, 16, v120
    v_and_b32 v9, s61, v120
    v_lshlrev_b32 v10, 16, v121
    v_and_b32 v11, s61, v121
    v_lshlrev_b32 v12, 16, v122
    v_and_b32 v13, s61, v122
    v_lshlrev_b32 v14, 16, v123
    v_and_b32 v15, s61, v123
    v_lshlrev_b32 v16, 16, v124
    v_and_b32 v17, s61, v124
    buffer_load_dwordx4 v[44:47], v5, s[24:27], s34 offen offset:1024
    v_lshlrev_b32 v18, 16, v125
    v_and_b32 v19, s61, v125
    v_lshlrev_b32 v20, 16, v126
    v_and_b32 v21, s61, v126
    v_lshlrev_b32 v22, 16, v127
    v_and_b32 v23, s61, v127
    v_lshlrev_b32 v24, 16, v128
    v_and_b32 v25, s61, v128
    v_lshlrev_b32 v26, 16, v129
    v_and_b32 v27, s61, v129
    v_add_f32 v32, v32, v33
    v_cvt_pk_bf16_f32 v32, v32, v32
    v_lshlrev_b32 v32, 16, v32
    v_add_f32 v32, s62, v32
    v_cvt_pk_bf16_f32 v32, v32, v32
    v_lshlrev_b32 v32, 16, v32
    v_rcp_f32 v32, v32
    buffer_load_dwordx4 v[48:51], v5, s[24:27], s34 offen offset:2048
    v_mul_f32 v8, v8, v32
    v_mul_f32 v9, v9, v32
    v_cvt_pk_bf16_f32 v120, v8, v9
    v_mul_f32 v10, v10, v32
    v_mul_f32 v11, v11, v32
    v_cvt_pk_bf16_f32 v121, v10, v11
    v_mul_f32 v12, v12, v32
    v_mul_f32 v13, v13, v32
    v_cvt_pk_bf16_f32 v122, v12, v13
    v_mul_f32 v14, v14, v32
    v_mul_f32 v15, v15, v32
    v_cvt_pk_bf16_f32 v123, v14, v15
    buffer_load_dwordx4 v[52:55], v5, s[24:27], s34 offen offset:3072
    v_mul_f32 v16, v16, v32
    v_mul_f32 v17, v17, v32
    v_cvt_pk_bf16_f32 v124, v16, v17
    v_mul_f32 v18, v18, v32
    v_mul_f32 v19, v19, v32
    v_cvt_pk_bf16_f32 v125, v18, v19
    v_mul_f32 v20, v20, v32
    v_mul_f32 v21, v21, v32
    v_cvt_pk_bf16_f32 v126, v20, v21
    v_mul_f32 v22, v22, v32
    v_mul_f32 v23, v23, v32
    v_cvt_pk_bf16_f32 v127, v22, v23
    v_mul_f32 v24, v24, v32
    v_mul_f32 v25, v25, v32
    v_cvt_pk_bf16_f32 v128, v24, v25
    s_add_u32 s34, s34, 4096
    buffer_load_dwordx4 v[56:59], v5, s[24:27], s34 offen offset:0
    v_mul_f32 v26, v26, v32
    v_mul_f32 v27, v27, v32
    v_cvt_pk_bf16_f32 v129, v26, v27
    ds_write_b64 v6, v[120:121] offset:0
    ds_write_b64 v6, v[122:123] offset:128
    ds_write_b64 v6, v[124:125] offset:256
    ds_write_b64 v6, v[126:127] offset:384
    ds_write_b64 v6, v[128:129] offset:512
    ds_read_b64 v[120:121], v6 offset:1280
    ds_read_b64 v[140:141], v7 offset:80
    ds_read_b64 v[122:123], v6 offset:1408
    ds_read_b64 v[142:143], v7 offset:88
    ds_read_b64 v[124:125], v6 offset:1536
    ds_read_b64 v[144:145], v7 offset:96
    ds_read_b64 v[126:127], v6 offset:1664
    ds_read_b64 v[146:147], v7 offset:104
    ds_read_b64 v[128:129], v6 offset:1792
    ds_read_b64 v[148:149], v7 offset:112
    s_waitcnt lgkmcnt(15)
    v_dot2_f32_bf16 v32, v130, v150, 0
    v_dot2_f32_bf16 v33, v131, v151, 0
    v_dot2_f32_bf16 v32, v132, v152, v32
    v_dot2_f32_bf16 v33, v133, v153, v33
    v_dot2_f32_bf16 v32, v134, v154, v32
    v_dot2_f32_bf16 v33, v135, v155, v33
    v_dot2_f32_bf16 v32, v136, v156, v32
    v_dot2_f32_bf16 v33, v137, v157, v33
    v_dot2_f32_bf16 v32, v138, v158, v32
    v_dot2_f32_bf16 v33, v139, v159, v33
    buffer_load_dwordx4 v[60:63], v5, s[24:27], s34 offen offset:1024
    v_lshlrev_b32 v8, 16, v130
    v_and_b32 v9, s61, v130
    v_lshlrev_b32 v10, 16, v131
    v_and_b32 v11, s61, v131
    v_lshlrev_b32 v12, 16, v132
    v_and_b32 v13, s61, v132
    v_lshlrev_b32 v14, 16, v133
    v_and_b32 v15, s61, v133
    v_lshlrev_b32 v16, 16, v134
    v_and_b32 v17, s61, v134
    buffer_load_dwordx4 v[64:67], v5, s[24:27], s34 offen offset:2048
    v_lshlrev_b32 v18, 16, v135
    v_and_b32 v19, s61, v135
    v_lshlrev_b32 v20, 16, v136
    v_and_b32 v21, s61, v136
    v_lshlrev_b32 v22, 16, v137
    v_and_b32 v23, s61, v137
    v_lshlrev_b32 v24, 16, v138
    v_and_b32 v25, s61, v138
    v_lshlrev_b32 v26, 16, v139
    v_and_b32 v27, s61, v139
    v_add_f32 v32, v32, v33
    v_cvt_pk_bf16_f32 v32, v32, v32
    v_lshlrev_b32 v32, 16, v32
    v_add_f32 v32, s62, v32
    v_cvt_pk_bf16_f32 v32, v32, v32
    v_lshlrev_b32 v32, 16, v32
    v_rcp_f32 v32, v32
    buffer_load_dwordx4 v[68:71], v5, s[24:27], s34 offen offset:3072
    v_mul_f32 v8, v8, v32
    v_mul_f32 v9, v9, v32
    v_cvt_pk_bf16_f32 v130, v8, v9
    v_mul_f32 v10, v10, v32
    v_mul_f32 v11, v11, v32
    v_cvt_pk_bf16_f32 v131, v10, v11
    v_mul_f32 v12, v12, v32
    v_mul_f32 v13, v13, v32
    v_cvt_pk_bf16_f32 v132, v12, v13
    v_mul_f32 v14, v14, v32
    v_mul_f32 v15, v15, v32
    v_cvt_pk_bf16_f32 v133, v14, v15
    s_add_u32 s34, s34, 4096
    buffer_load_dwordx4 v[72:75], v5, s[24:27], s34 offen offset:0
    v_mul_f32 v16, v16, v32
    v_mul_f32 v17, v17, v32
    v_cvt_pk_bf16_f32 v134, v16, v17
    v_mul_f32 v18, v18, v32
    v_mul_f32 v19, v19, v32
    v_cvt_pk_bf16_f32 v135, v18, v19
    v_mul_f32 v20, v20, v32
    v_mul_f32 v21, v21, v32
    v_cvt_pk_bf16_f32 v136, v20, v21
    v_mul_f32 v22, v22, v32
    v_mul_f32 v23, v23, v32
    v_cvt_pk_bf16_f32 v137, v22, v23
    v_mul_f32 v24, v24, v32
    v_mul_f32 v25, v25, v32
    v_cvt_pk_bf16_f32 v138, v24, v25
    buffer_load_dwordx4 v[76:79], v5, s[24:27], s34 offen offset:1024
    v_mul_f32 v26, v26, v32
    v_mul_f32 v27, v27, v32
    v_cvt_pk_bf16_f32 v139, v26, v27
    ds_write_b64 v6, v[130:131] offset:640
    ds_write_b64 v6, v[132:133] offset:768
    ds_write_b64 v6, v[134:135] offset:896
    ds_write_b64 v6, v[136:137] offset:1024
    ds_write_b64 v6, v[138:139] offset:1152
    ds_read_b64 v[130:131], v6 offset:1920
    ds_read_b64 v[150:151], v7 offset:120
    ds_read_b64 v[132:133], v6 offset:2048
    ds_read_b64 v[152:153], v7 offset:128
    ds_read_b64 v[134:135], v6 offset:2176
    ds_read_b64 v[154:155], v7 offset:136
    ds_read_b64 v[136:137], v6 offset:2304
    ds_read_b64 v[156:157], v7 offset:144
    ds_read_b64 v[138:139], v6 offset:2432
    ds_read_b64 v[158:159], v7 offset:152
    s_waitcnt lgkmcnt(15)
    v_dot2_f32_bf16 v32, v120, v140, 0
    v_dot2_f32_bf16 v33, v121, v141, 0
    v_dot2_f32_bf16 v32, v122, v142, v32
    v_dot2_f32_bf16 v33, v123, v143, v33
    v_dot2_f32_bf16 v32, v124, v144, v32
    v_dot2_f32_bf16 v33, v125, v145, v33
    v_dot2_f32_bf16 v32, v126, v146, v32
    v_dot2_f32_bf16 v33, v127, v147, v33
    v_dot2_f32_bf16 v32, v128, v148, v32
    v_dot2_f32_bf16 v33, v129, v149, v33
    buffer_load_dwordx4 v[80:83], v5, s[24:27], s34 offen offset:2048
    v_lshlrev_b32 v8, 16, v120
    v_and_b32 v9, s61, v120
    v_lshlrev_b32 v10, 16, v121
    v_and_b32 v11, s61, v121
    v_lshlrev_b32 v12, 16, v122
    v_and_b32 v13, s61, v122
    v_lshlrev_b32 v14, 16, v123
    v_and_b32 v15, s61, v123
    v_lshlrev_b32 v16, 16, v124
    v_and_b32 v17, s61, v124
    buffer_load_dwordx4 v[84:87], v5, s[24:27], s34 offen offset:3072
    v_lshlrev_b32 v18, 16, v125
    v_and_b32 v19, s61, v125
    v_lshlrev_b32 v20, 16, v126
    v_and_b32 v21, s61, v126
    v_lshlrev_b32 v22, 16, v127
    v_and_b32 v23, s61, v127
    v_lshlrev_b32 v24, 16, v128
    v_and_b32 v25, s61, v128
    v_lshlrev_b32 v26, 16, v129
    v_and_b32 v27, s61, v129
    v_add_f32 v32, v32, v33
    v_cvt_pk_bf16_f32 v32, v32, v32
    v_lshlrev_b32 v32, 16, v32
    v_add_f32 v32, s62, v32
    v_cvt_pk_bf16_f32 v32, v32, v32
    v_lshlrev_b32 v32, 16, v32
    v_rcp_f32 v32, v32
    s_add_u32 s34, s34, 4096
    buffer_load_dwordx4 v[88:91], v5, s[24:27], s34 offen offset:0
    v_mul_f32 v8, v8, v32
    v_mul_f32 v9, v9, v32
    v_cvt_pk_bf16_f32 v120, v8, v9
    v_mul_f32 v10, v10, v32
    v_mul_f32 v11, v11, v32
    v_cvt_pk_bf16_f32 v121, v10, v11
    v_mul_f32 v12, v12, v32
    v_mul_f32 v13, v13, v32
    v_cvt_pk_bf16_f32 v122, v12, v13
    v_mul_f32 v14, v14, v32
    v_mul_f32 v15, v15, v32
    v_cvt_pk_bf16_f32 v123, v14, v15
    buffer_load_dwordx4 v[92:95], v5, s[24:27], s34 offen offset:1024
    v_mul_f32 v16, v16, v32
    v_mul_f32 v17, v17, v32
    v_cvt_pk_bf16_f32 v124, v16, v17
    v_mul_f32 v18, v18, v32
    v_mul_f32 v19, v19, v32
    v_cvt_pk_bf16_f32 v125, v18, v19
    v_mul_f32 v20, v20, v32
    v_mul_f32 v21, v21, v32
    v_cvt_pk_bf16_f32 v126, v20, v21
    v_mul_f32 v22, v22, v32
    v_mul_f32 v23, v23, v32
    v_cvt_pk_bf16_f32 v127, v22, v23
    v_mul_f32 v24, v24, v32
    v_mul_f32 v25, v25, v32
    v_cvt_pk_bf16_f32 v128, v24, v25
    buffer_load_dwordx4 v[96:99], v5, s[24:27], s34 offen offset:2048
    v_mul_f32 v26, v26, v32
    v_mul_f32 v27, v27, v32
    v_cvt_pk_bf16_f32 v129, v26, v27
    ds_write_b64 v6, v[120:121] offset:1280
    ds_write_b64 v6, v[122:123] offset:1408
    ds_write_b64 v6, v[124:125] offset:1536
    ds_write_b64 v6, v[126:127] offset:1664
    ds_write_b64 v6, v[128:129] offset:1792
    s_waitcnt lgkmcnt(0)
    v_dot2_f32_bf16 v32, v130, v150, 0
    v_dot2_f32_bf16 v33, v131, v151, 0
    v_dot2_f32_bf16 v32, v132, v152, v32
    v_dot2_f32_bf16 v33, v133, v153, v33
    v_dot2_f32_bf16 v32, v134, v154, v32
    v_dot2_f32_bf16 v33, v135, v155, v33
    v_dot2_f32_bf16 v32, v136, v156, v32
    v_dot2_f32_bf16 v33, v137, v157, v33
    v_dot2_f32_bf16 v32, v138, v158, v32
    v_dot2_f32_bf16 v33, v139, v159, v33
    buffer_load_dwordx4 v[100:103], v5, s[24:27], s34 offen offset:3072
    v_lshlrev_b32 v8, 16, v130
    v_and_b32 v9, s61, v130
    v_lshlrev_b32 v10, 16, v131
    v_and_b32 v11, s61, v131
    v_lshlrev_b32 v12, 16, v132
    v_and_b32 v13, s61, v132
    v_lshlrev_b32 v14, 16, v133
    v_and_b32 v15, s61, v133
    v_lshlrev_b32 v16, 16, v134
    v_and_b32 v17, s61, v134
    s_add_u32 s34, s34, 4096
    buffer_load_dwordx4 v[104:107], v5, s[24:27], s34 offen offset:0
    v_lshlrev_b32 v18, 16, v135
    v_and_b32 v19, s61, v135
    v_lshlrev_b32 v20, 16, v136
    v_and_b32 v21, s61, v136
    v_lshlrev_b32 v22, 16, v137
    v_and_b32 v23, s61, v137
    v_lshlrev_b32 v24, 16, v138
    v_and_b32 v25, s61, v138
    v_lshlrev_b32 v26, 16, v139
    v_and_b32 v27, s61, v139
    v_add_f32 v32, v32, v33
    v_cvt_pk_bf16_f32 v32, v32, v32
    v_lshlrev_b32 v32, 16, v32
    v_add_f32 v32, s62, v32
    v_cvt_pk_bf16_f32 v32, v32, v32
    v_lshlrev_b32 v32, 16, v32
    v_rcp_f32 v32, v32
    buffer_load_dwordx4 v[108:111], v5, s[24:27], s34 offen offset:1024
    v_mul_f32 v8, v8, v32
    v_mul_f32 v9, v9, v32
    v_cvt_pk_bf16_f32 v130, v8, v9
    v_mul_f32 v10, v10, v32
    v_mul_f32 v11, v11, v32
    v_cvt_pk_bf16_f32 v131, v10, v11
    v_mul_f32 v12, v12, v32
    v_mul_f32 v13, v13, v32
    v_cvt_pk_bf16_f32 v132, v12, v13
    v_mul_f32 v14, v14, v32
    v_mul_f32 v15, v15, v32
    v_cvt_pk_bf16_f32 v133, v14, v15
    buffer_load_dwordx4 v[112:115], v5, s[24:27], s34 offen offset:2048
    v_mul_f32 v16, v16, v32
    v_mul_f32 v17, v17, v32
    v_cvt_pk_bf16_f32 v134, v16, v17
    v_mul_f32 v18, v18, v32
    v_mul_f32 v19, v19, v32
    v_cvt_pk_bf16_f32 v135, v18, v19
    v_mul_f32 v20, v20, v32
    v_mul_f32 v21, v21, v32
    v_cvt_pk_bf16_f32 v136, v20, v21
    v_mul_f32 v22, v22, v32
    v_mul_f32 v23, v23, v32
    v_cvt_pk_bf16_f32 v137, v22, v23
    v_mul_f32 v24, v24, v32
    v_mul_f32 v25, v25, v32
    v_cvt_pk_bf16_f32 v138, v24, v25
    buffer_load_dwordx4 v[116:119], v5, s[24:27], s34 offen offset:3072
    v_mul_f32 v26, v26, v32
    v_mul_f32 v27, v27, v32
    v_cvt_pk_bf16_f32 v139, v26, v27
    ds_write_b64 v6, v[130:131] offset:1920
    ds_write_b64 v6, v[132:133] offset:2048
    ds_write_b64 v6, v[134:135] offset:2176
    ds_write_b64 v6, v[136:137] offset:2304
    ds_write_b64 v6, v[138:139] offset:2432
    s_waitcnt lgkmcnt(0)
    s_barrier
    v_lshlrev_b32 v6, 3, v1
    v_add_u32 v7, 40960, v6
    v_mov_b32 v8, 0
    v_mov_b32 v9, 0
    v_mov_b32 v10, 0
    v_mov_b32 v11, 0
    v_mov_b32 v12, 0
    v_mov_b32 v13, 0
    v_mov_b32 v14, 0
    v_mov_b32 v15, 0
    v_mov_b32 v16, 0
    v_mov_b32 v17, 0
    v_mov_b32 v18, 0
    v_mov_b32 v19, 0
    v_mov_b32 v20, 0
    v_mov_b32 v21, 0
    v_mov_b32 v22, 0
    v_mov_b32 v23, 0
    ds_read_b64 v[120:121], v6 offset:0
    ds_read_b64 v[122:123], v6 offset:512
    ds_read_b64 v[124:125], v6 offset:20480
    ds_read_b64 v[126:127], v6 offset:20992
    ds_read_b64 v[128:129], v7 offset:0
    ds_read_b64 v[130:131], v7 offset:512
    ds_read_b64 v[132:133], v7 offset:20480
    ds_read_b64 v[134:135], v7 offset:20992
    ds_read_b64 v[136:137], v6 offset:1024
    ds_read_b64 v[138:139], v6 offset:1536
    ds_read_b64 v[140:141], v6 offset:21504
    ds_read_b64 v[142:143], v6 offset:22016
    ds_read_b64 v[144:145], v7 offset:1024
    ds_read_b64 v[146:147], v7 offset:1536
    ds_read_b64 v[148:149], v7 offset:21504
    ds_read_b64 v[150:151], v7 offset:22016
    s_waitcnt vmcnt(19) lgkmcnt(8)
    v_mfma_f32_16x16x32_bf16 v[8:11], v[40:43], v[120:123], v[8:11]
    v_mfma_f32_16x16x32_bf16 v[12:15], v[40:43], v[124:127], v[12:15]
    v_mfma_f32_16x16x32_bf16 v[16:19], v[40:43], v[128:131], v[16:19]
    v_mfma_f32_16x16x32_bf16 v[20:23], v[40:43], v[132:135], v[20:23]
    ds_read_b64 v[152:153], v6 offset:2048
    ds_read_b64 v[154:155], v6 offset:2560
    ds_read_b64 v[156:157], v6 offset:22528
    ds_read_b64 v[158:159], v6 offset:23040
    ds_read_b64 v[160:161], v7 offset:2048
    ds_read_b64 v[162:163], v7 offset:2560
    ds_read_b64 v[164:165], v7 offset:22528
    ds_read_b64 v[166:167], v7 offset:23040
    s_waitcnt vmcnt(18) lgkmcnt(8)
    v_mfma_f32_16x16x32_bf16 v[8:11], v[44:47], v[136:139], v[8:11]
    v_mfma_f32_16x16x32_bf16 v[12:15], v[44:47], v[140:143], v[12:15]
    v_mfma_f32_16x16x32_bf16 v[16:19], v[44:47], v[144:147], v[16:19]
    v_mfma_f32_16x16x32_bf16 v[20:23], v[44:47], v[148:151], v[20:23]
    ds_read_b64 v[120:121], v6 offset:3072
    ds_read_b64 v[122:123], v6 offset:3584
    ds_read_b64 v[124:125], v6 offset:23552
    ds_read_b64 v[126:127], v6 offset:24064
    ds_read_b64 v[128:129], v7 offset:3072
    ds_read_b64 v[130:131], v7 offset:3584
    ds_read_b64 v[132:133], v7 offset:23552
    ds_read_b64 v[134:135], v7 offset:24064
    s_waitcnt vmcnt(17) lgkmcnt(8)
    v_mfma_f32_16x16x32_bf16 v[8:11], v[48:51], v[152:155], v[8:11]
    v_mfma_f32_16x16x32_bf16 v[12:15], v[48:51], v[156:159], v[12:15]
    v_mfma_f32_16x16x32_bf16 v[16:19], v[48:51], v[160:163], v[16:19]
    v_mfma_f32_16x16x32_bf16 v[20:23], v[48:51], v[164:167], v[20:23]
    ds_read_b64 v[136:137], v6 offset:4096
    ds_read_b64 v[138:139], v6 offset:4608
    ds_read_b64 v[140:141], v6 offset:24576
    ds_read_b64 v[142:143], v6 offset:25088
    ds_read_b64 v[144:145], v7 offset:4096
    ds_read_b64 v[146:147], v7 offset:4608
    ds_read_b64 v[148:149], v7 offset:24576
    ds_read_b64 v[150:151], v7 offset:25088
    s_waitcnt vmcnt(16) lgkmcnt(8)
    v_mfma_f32_16x16x32_bf16 v[8:11], v[52:55], v[120:123], v[8:11]
    v_mfma_f32_16x16x32_bf16 v[12:15], v[52:55], v[124:127], v[12:15]
    v_mfma_f32_16x16x32_bf16 v[16:19], v[52:55], v[128:131], v[16:19]
    v_mfma_f32_16x16x32_bf16 v[20:23], v[52:55], v[132:135], v[20:23]
    ds_read_b64 v[152:153], v6 offset:5120
    ds_read_b64 v[154:155], v6 offset:5632
    ds_read_b64 v[156:157], v6 offset:25600
    ds_read_b64 v[158:159], v6 offset:26112
    ds_read_b64 v[160:161], v7 offset:5120
    ds_read_b64 v[162:163], v7 offset:5632
    ds_read_b64 v[164:165], v7 offset:25600
    ds_read_b64 v[166:167], v7 offset:26112
    s_waitcnt vmcnt(15) lgkmcnt(8)
    v_mfma_f32_16x16x32_bf16 v[8:11], v[56:59], v[136:139], v[8:11]
    v_mfma_f32_16x16x32_bf16 v[12:15], v[56:59], v[140:143], v[12:15]
    v_mfma_f32_16x16x32_bf16 v[16:19], v[56:59], v[144:147], v[16:19]
    v_mfma_f32_16x16x32_bf16 v[20:23], v[56:59], v[148:151], v[20:23]
    ds_read_b64 v[120:121], v6 offset:6144
    ds_read_b64 v[122:123], v6 offset:6656
    ds_read_b64 v[124:125], v6 offset:26624
    ds_read_b64 v[126:127], v6 offset:27136
    ds_read_b64 v[128:129], v7 offset:6144
    ds_read_b64 v[130:131], v7 offset:6656
    ds_read_b64 v[132:133], v7 offset:26624
    ds_read_b64 v[134:135], v7 offset:27136
    s_waitcnt vmcnt(14) lgkmcnt(8)
    v_mfma_f32_16x16x32_bf16 v[8:11], v[60:63], v[152:155], v[8:11]
    v_mfma_f32_16x16x32_bf16 v[12:15], v[60:63], v[156:159], v[12:15]
    v_mfma_f32_16x16x32_bf16 v[16:19], v[60:63], v[160:163], v[16:19]
    v_mfma_f32_16x16x32_bf16 v[20:23], v[60:63], v[164:167], v[20:23]
    ds_read_b64 v[136:137], v6 offset:7168
    ds_read_b64 v[138:139], v6 offset:7680
    ds_read_b64 v[140:141], v6 offset:27648
    ds_read_b64 v[142:143], v6 offset:28160
    ds_read_b64 v[144:145], v7 offset:7168
    ds_read_b64 v[146:147], v7 offset:7680
    ds_read_b64 v[148:149], v7 offset:27648
    ds_read_b64 v[150:151], v7 offset:28160
    s_waitcnt vmcnt(13) lgkmcnt(8)
    v_mfma_f32_16x16x32_bf16 v[8:11], v[64:67], v[120:123], v[8:11]
    v_mfma_f32_16x16x32_bf16 v[12:15], v[64:67], v[124:127], v[12:15]
    v_mfma_f32_16x16x32_bf16 v[16:19], v[64:67], v[128:131], v[16:19]
    v_mfma_f32_16x16x32_bf16 v[20:23], v[64:67], v[132:135], v[20:23]
    ds_read_b64 v[152:153], v6 offset:8192
    ds_read_b64 v[154:155], v6 offset:8704
    ds_read_b64 v[156:157], v6 offset:28672
    ds_read_b64 v[158:159], v6 offset:29184
    ds_read_b64 v[160:161], v7 offset:8192
    ds_read_b64 v[162:163], v7 offset:8704
    ds_read_b64 v[164:165], v7 offset:28672
    ds_read_b64 v[166:167], v7 offset:29184
    s_waitcnt vmcnt(12) lgkmcnt(8)
    v_mfma_f32_16x16x32_bf16 v[8:11], v[68:71], v[136:139], v[8:11]
    v_mfma_f32_16x16x32_bf16 v[12:15], v[68:71], v[140:143], v[12:15]
    v_mfma_f32_16x16x32_bf16 v[16:19], v[68:71], v[144:147], v[16:19]
    v_mfma_f32_16x16x32_bf16 v[20:23], v[68:71], v[148:151], v[20:23]
    ds_read_b64 v[120:121], v6 offset:9216
    ds_read_b64 v[122:123], v6 offset:9728
    ds_read_b64 v[124:125], v6 offset:29696
    ds_read_b64 v[126:127], v6 offset:30208
    ds_read_b64 v[128:129], v7 offset:9216
    ds_read_b64 v[130:131], v7 offset:9728
    ds_read_b64 v[132:133], v7 offset:29696
    ds_read_b64 v[134:135], v7 offset:30208
    s_waitcnt vmcnt(11) lgkmcnt(8)
    v_mfma_f32_16x16x32_bf16 v[8:11], v[72:75], v[152:155], v[8:11]
    v_mfma_f32_16x16x32_bf16 v[12:15], v[72:75], v[156:159], v[12:15]
    v_mfma_f32_16x16x32_bf16 v[16:19], v[72:75], v[160:163], v[16:19]
    v_mfma_f32_16x16x32_bf16 v[20:23], v[72:75], v[164:167], v[20:23]
    ds_read_b64 v[136:137], v6 offset:10240
    ds_read_b64 v[138:139], v6 offset:10752
    ds_read_b64 v[140:141], v6 offset:30720
    ds_read_b64 v[142:143], v6 offset:31232
    ds_read_b64 v[144:145], v7 offset:10240
    ds_read_b64 v[146:147], v7 offset:10752
    ds_read_b64 v[148:149], v7 offset:30720
    ds_read_b64 v[150:151], v7 offset:31232
    s_waitcnt vmcnt(10) lgkmcnt(8)
    v_mfma_f32_16x16x32_bf16 v[8:11], v[76:79], v[120:123], v[8:11]
    v_mfma_f32_16x16x32_bf16 v[12:15], v[76:79], v[124:127], v[12:15]
    v_mfma_f32_16x16x32_bf16 v[16:19], v[76:79], v[128:131], v[16:19]
    v_mfma_f32_16x16x32_bf16 v[20:23], v[76:79], v[132:135], v[20:23]
    ds_read_b64 v[152:153], v6 offset:11264
    ds_read_b64 v[154:155], v6 offset:11776
    ds_read_b64 v[156:157], v6 offset:31744
    ds_read_b64 v[158:159], v6 offset:32256
    ds_read_b64 v[160:161], v7 offset:11264
    ds_read_b64 v[162:163], v7 offset:11776
    ds_read_b64 v[164:165], v7 offset:31744
    ds_read_b64 v[166:167], v7 offset:32256
    s_waitcnt vmcnt(9) lgkmcnt(8)
    v_mfma_f32_16x16x32_bf16 v[8:11], v[80:83], v[136:139], v[8:11]
    v_mfma_f32_16x16x32_bf16 v[12:15], v[80:83], v[140:143], v[12:15]
    v_mfma_f32_16x16x32_bf16 v[16:19], v[80:83], v[144:147], v[16:19]
    v_mfma_f32_16x16x32_bf16 v[20:23], v[80:83], v[148:151], v[20:23]
    ds_read_b64 v[120:121], v6 offset:12288
    ds_read_b64 v[122:123], v6 offset:12800
    ds_read_b64 v[124:125], v6 offset:32768
    ds_read_b64 v[126:127], v6 offset:33280
    ds_read_b64 v[128:129], v7 offset:12288
    ds_read_b64 v[130:131], v7 offset:12800
    ds_read_b64 v[132:133], v7 offset:32768
    ds_read_b64 v[134:135], v7 offset:33280
    s_waitcnt vmcnt(8) lgkmcnt(8)
    v_mfma_f32_16x16x32_bf16 v[8:11], v[84:87], v[152:155], v[8:11]
    v_mfma_f32_16x16x32_bf16 v[12:15], v[84:87], v[156:159], v[12:15]
    v_mfma_f32_16x16x32_bf16 v[16:19], v[84:87], v[160:163], v[16:19]
    v_mfma_f32_16x16x32_bf16 v[20:23], v[84:87], v[164:167], v[20:23]
    ds_read_b64 v[136:137], v6 offset:13312
    ds_read_b64 v[138:139], v6 offset:13824
    ds_read_b64 v[140:141], v6 offset:33792
    ds_read_b64 v[142:143], v6 offset:34304
    ds_read_b64 v[144:145], v7 offset:13312
    ds_read_b64 v[146:147], v7 offset:13824
    ds_read_b64 v[148:149], v7 offset:33792
    ds_read_b64 v[150:151], v7 offset:34304
    s_waitcnt vmcnt(7) lgkmcnt(8)
    v_mfma_f32_16x16x32_bf16 v[8:11], v[88:91], v[120:123], v[8:11]
    v_mfma_f32_16x16x32_bf16 v[12:15], v[88:91], v[124:127], v[12:15]
    v_mfma_f32_16x16x32_bf16 v[16:19], v[88:91], v[128:131], v[16:19]
    v_mfma_f32_16x16x32_bf16 v[20:23], v[88:91], v[132:135], v[20:23]
    ds_read_b64 v[152:153], v6 offset:14336
    ds_read_b64 v[154:155], v6 offset:14848
    ds_read_b64 v[156:157], v6 offset:34816
    ds_read_b64 v[158:159], v6 offset:35328
    ds_read_b64 v[160:161], v7 offset:14336
    ds_read_b64 v[162:163], v7 offset:14848
    ds_read_b64 v[164:165], v7 offset:34816
    ds_read_b64 v[166:167], v7 offset:35328
    s_waitcnt vmcnt(6) lgkmcnt(8)
    v_mfma_f32_16x16x32_bf16 v[8:11], v[92:95], v[136:139], v[8:11]
    v_mfma_f32_16x16x32_bf16 v[12:15], v[92:95], v[140:143], v[12:15]
    v_mfma_f32_16x16x32_bf16 v[16:19], v[92:95], v[144:147], v[16:19]
    v_mfma_f32_16x16x32_bf16 v[20:23], v[92:95], v[148:151], v[20:23]
    ds_read_b64 v[120:121], v6 offset:15360
    ds_read_b64 v[122:123], v6 offset:15872
    ds_read_b64 v[124:125], v6 offset:35840
    ds_read_b64 v[126:127], v6 offset:36352
    ds_read_b64 v[128:129], v7 offset:15360
    ds_read_b64 v[130:131], v7 offset:15872
    ds_read_b64 v[132:133], v7 offset:35840
    ds_read_b64 v[134:135], v7 offset:36352
    s_waitcnt vmcnt(5) lgkmcnt(8)
    v_mfma_f32_16x16x32_bf16 v[8:11], v[96:99], v[152:155], v[8:11]
    v_mfma_f32_16x16x32_bf16 v[12:15], v[96:99], v[156:159], v[12:15]
    v_mfma_f32_16x16x32_bf16 v[16:19], v[96:99], v[160:163], v[16:19]
    v_mfma_f32_16x16x32_bf16 v[20:23], v[96:99], v[164:167], v[20:23]
    ds_read_b64 v[136:137], v6 offset:16384
    ds_read_b64 v[138:139], v6 offset:16896
    ds_read_b64 v[140:141], v6 offset:36864
    ds_read_b64 v[142:143], v6 offset:37376
    ds_read_b64 v[144:145], v7 offset:16384
    ds_read_b64 v[146:147], v7 offset:16896
    ds_read_b64 v[148:149], v7 offset:36864
    ds_read_b64 v[150:151], v7 offset:37376
    s_waitcnt vmcnt(4) lgkmcnt(8)
    v_mfma_f32_16x16x32_bf16 v[8:11], v[100:103], v[120:123], v[8:11]
    v_mfma_f32_16x16x32_bf16 v[12:15], v[100:103], v[124:127], v[12:15]
    v_mfma_f32_16x16x32_bf16 v[16:19], v[100:103], v[128:131], v[16:19]
    v_mfma_f32_16x16x32_bf16 v[20:23], v[100:103], v[132:135], v[20:23]
    ds_read_b64 v[152:153], v6 offset:17408
    ds_read_b64 v[154:155], v6 offset:17920
    ds_read_b64 v[156:157], v6 offset:37888
    ds_read_b64 v[158:159], v6 offset:38400
    ds_read_b64 v[160:161], v7 offset:17408
    ds_read_b64 v[162:163], v7 offset:17920
    ds_read_b64 v[164:165], v7 offset:37888
    ds_read_b64 v[166:167], v7 offset:38400
    s_waitcnt vmcnt(3) lgkmcnt(8)
    v_mfma_f32_16x16x32_bf16 v[8:11], v[104:107], v[136:139], v[8:11]
    v_mfma_f32_16x16x32_bf16 v[12:15], v[104:107], v[140:143], v[12:15]
    v_mfma_f32_16x16x32_bf16 v[16:19], v[104:107], v[144:147], v[16:19]
    v_mfma_f32_16x16x32_bf16 v[20:23], v[104:107], v[148:151], v[20:23]
    ds_read_b64 v[120:121], v6 offset:18432
    ds_read_b64 v[122:123], v6 offset:18944
    ds_read_b64 v[124:125], v6 offset:38912
    ds_read_b64 v[126:127], v6 offset:39424
    ds_read_b64 v[128:129], v7 offset:18432
    ds_read_b64 v[130:131], v7 offset:18944
    ds_read_b64 v[132:133], v7 offset:38912
    ds_read_b64 v[134:135], v7 offset:39424
    s_waitcnt vmcnt(2) lgkmcnt(8)
    v_mfma_f32_16x16x32_bf16 v[8:11], v[108:111], v[152:155], v[8:11]
    v_mfma_f32_16x16x32_bf16 v[12:15], v[108:111], v[156:159], v[12:15]
    v_mfma_f32_16x16x32_bf16 v[16:19], v[108:111], v[160:163], v[16:19]
    v_mfma_f32_16x16x32_bf16 v[20:23], v[108:111], v[164:167], v[20:23]
    ds_read_b64 v[136:137], v6 offset:19456
    ds_read_b64 v[138:139], v6 offset:19968
    ds_read_b64 v[140:141], v6 offset:39936
    ds_read_b64 v[142:143], v6 offset:40448
    ds_read_b64 v[144:145], v7 offset:19456
    ds_read_b64 v[146:147], v7 offset:19968
    ds_read_b64 v[148:149], v7 offset:39936
    ds_read_b64 v[150:151], v7 offset:40448
    s_waitcnt vmcnt(1) lgkmcnt(8)
    v_mfma_f32_16x16x32_bf16 v[8:11], v[112:115], v[120:123], v[8:11]
    v_mfma_f32_16x16x32_bf16 v[12:15], v[112:115], v[124:127], v[12:15]
    v_mfma_f32_16x16x32_bf16 v[16:19], v[112:115], v[128:131], v[16:19]
    v_mfma_f32_16x16x32_bf16 v[20:23], v[112:115], v[132:135], v[20:23]
    s_waitcnt vmcnt(0) lgkmcnt(0)
    v_mfma_f32_16x16x32_bf16 v[8:11], v[116:119], v[136:139], v[8:11]
    v_mfma_f32_16x16x32_bf16 v[12:15], v[116:119], v[140:143], v[12:15]
    v_mfma_f32_16x16x32_bf16 v[16:19], v[116:119], v[144:147], v[16:19]
    v_mfma_f32_16x16x32_bf16 v[20:23], v[116:119], v[148:151], v[20:23]
    s_barrier
    v_lshrrev_b32 v40, 4, v1
    v_and_b32 v41, 15, v1
    v_mul_u32_u24 v42, 272, v41
    v_lshl_add_u32 v42, v40, 3, v42
    s_lshl_b32 s30, s4, 5
    v_add_u32 v42, s30, v42
    v_cvt_pk_bf16_f32 v8, v8, v9
    v_cvt_pk_bf16_f32 v9, v10, v11
    ds_write_b64 v42, v[8:9] offset:0
    v_cvt_pk_bf16_f32 v12, v12, v13
    v_cvt_pk_bf16_f32 v13, v14, v15
    ds_write_b64 v42, v[12:13] offset:4352
    v_cvt_pk_bf16_f32 v16, v16, v17
    v_cvt_pk_bf16_f32 v17, v18, v19
    ds_write_b64 v42, v[16:17] offset:8704
    v_cvt_pk_bf16_f32 v20, v20, v21
    v_cvt_pk_bf16_f32 v21, v22, v23
    ds_write_b64 v42, v[20:21] offset:13056
    s_waitcnt lgkmcnt(0)
    s_barrier
    v_lshrrev_b32 v40, 4, v0
    v_and_b32 v41, 15, v0
    v_mul_u32_u24 v42, 272, v40
    v_lshl_add_u32 v42, v41, 4, v42
    ds_read_b128 v[8:11], v42
    ds_read_b128 v[12:15], v42 offset:8704
    s_lshl_b32 s7, s5, 6
    v_add_u32 v40, s7, v40
    v_mul_u32_u24 v40, 2560, v40
    v_lshl_add_u32 v40, v41, 4, v40
    s_lshl_b32 s30, s6, 8
    s_add_u32 s31, s30, 81920
    s_waitcnt lgkmcnt(0)
    buffer_store_dwordx4 v[8:11], v40, s[16:19], s30 offen
    buffer_store_dwordx4 v[12:15], v40, s[16:19], s31 offen
    s_endpgm
L_k3_b:
    s_sub_u32 s3, s2, 160
    s_load_dwordx2 s[8:9], s[0:1], 24
    s_load_dwordx2 s[10:11], s[0:1], 72
    s_load_dwordx2 s[12:13], s[0:1], 80
    s_load_dwordx2 s[14:15], s[0:1], 96
    v_lshrrev_b32 v4, 8, v0
    s_nop 0
    v_readfirstlane_b32 s4, v4
    v_and_b32 v0, 255, v0
    v_and_b32 v1, 63, v0
    v_lshrrev_b32 v4, 6, v0
    s_mul_i32 s3, s3, 2
    s_add_u32 s3, s3, s4
    s_mul_i32 s5, s4, 9216
    s_waitcnt lgkmcnt(0)
    s_mov_b32 s16, s8
    s_mov_b32 s17, s9
    s_mov_b32 s18, 2621440
    s_mov_b32 s19, 0x00020000
    s_mov_b32 s20, s10
    s_mov_b32 s21, s11
    s_mov_b32 s22, 1280
    s_mov_b32 s23, 0x00020000
    s_mov_b32 s24, s12
    s_mov_b32 s25, s13
    s_mov_b32 s26, 5242880
    s_mov_b32 s27, 0x00020000
    s_mov_b32 s28, s14
    s_mov_b32 s29, s15
    s_mov_b32 s30, 33554432
    s_mov_b32 s31, 0x00020000
L_try_loop:
    s_mul_i32 s6, s3, 6554
    s_lshr_b32 s6, s6, 16
    s_mul_i32 s7, s6, 10
    s_sub_u32 s7, s3, s7
    v_lshrrev_b32 v5, 3, v0
    v_and_b32 v6, 7, v0
    v_lshlrev_b32 v7, 12, v5
    v_lshl_add_u32 v7, v6, 4, v7
    s_lshl_b32 s32, s7, 18
    s_lshl_b32 s33, s6, 7
    s_add_u32 s32, s32, s33
    s_add_u32 s32, s32, 15728640
    s_add_u32 s33, s32, 131072
    buffer_load_dwordx4 v[8:11], v7, s[28:31], s32 offen
    buffer_load_dwordx4 v[12:15], v7, s[28:31], s33 offen
    v_mul_u32_u24 v16, 144, v5
    v_lshl_add_u32 v16, v6, 4, v16
    v_add_u32 v16, s5, v16
    v_lshrrev_b32 v17, 4, v1
    v_bfe_u32 v18, v1, 2, 2
    v_and_b32 v19, 3, v1
    v_and_b32 v20, 15, v1
    v_lshl_add_u32 v21, v17, 3, v18
    v_mul_u32_u24 v21, 144, v21
    v_lshl_add_u32 v21, v19, 3, v21
    v_lshl_add_u32 v21, v4, 5, v21
    v_add_u32 v21, s5, v21
    v_lshl_add_u32 v22, v4, 4, v20
    v_mul_u32_u24 v23, 2560, v22
    v_lshl_add_u32 v23, v17, 4, v23
    s_mul_i32 s34, s6, 163840
    s_lshl_b32 s35, s7, 7
    s_add_u32 s34, s34, s35
    s_add_u32 s34, s34, 1280
    v_mul_u32_u24 v24, 1280, v22
    v_lshl_add_u32 v24, v17, 4, v24
    s_mul_i32 s36, s6, 81920
    s_add_u32 s36, s36, s35
    buffer_load_dwordx4 v[32:35], v24, s[16:19], s36 offen
    buffer_load_dwordx4 v[36:39], v24, s[16:19], s36 offen offset:64
    v_lshlrev_b32 v24, 4, v17
    buffer_load_dwordx4 v[40:43], v24, s[20:23], s35 offen
    buffer_load_dwordx4 v[44:47], v24, s[20:23], s35 offen offset:64
    s_waitcnt vmcnt(4)
    ds_write_b128 v16, v[8:11]
    ds_write_b128 v16, v[12:15] offset:4608
    s_waitcnt lgkmcnt(0)
    s_barrier
    ds_read_b64_tr_b16 v[8:9], v21 offset:0
    ds_read_b64_tr_b16 v[10:11], v21 offset:576
    ds_read_b64_tr_b16 v[12:13], v21 offset:4608
    ds_read_b64_tr_b16 v[14:15], v21 offset:5184
    s_waitcnt lgkmcnt(0)
    s_mov_b32 s38, 0xffff0000
    s_waitcnt vmcnt(0)
    v_lshlrev_b32 v48, 16, v32
    v_and_b32 v49, s38, v32
    v_lshlrev_b32 v50, 16, v40
    v_and_b32 v51, s38, v40
    v_mul_f32 v48, v48, v50
    v_mul_f32 v49, v49, v51
    v_cvt_pk_bf16_f32 v48, v48, v49
    v_and_b32 v49, s38, v48
    v_lshlrev_b32 v48, 16, v48
    v_lshlrev_b32 v50, 16, v8
    v_and_b32 v51, s38, v8
    v_add_f32 v48, v48, v50
    v_add_f32 v49, v49, v51
    v_cvt_pk_bf16_f32 v8, v48, v49
    v_lshlrev_b32 v48, 16, v33
    v_and_b32 v49, s38, v33
    v_lshlrev_b32 v50, 16, v41
    v_and_b32 v51, s38, v41
    v_mul_f32 v48, v48, v50
    v_mul_f32 v49, v49, v51
    v_cvt_pk_bf16_f32 v48, v48, v49
    v_and_b32 v49, s38, v48
    v_lshlrev_b32 v48, 16, v48
    v_lshlrev_b32 v50, 16, v9
    v_and_b32 v51, s38, v9
    v_add_f32 v48, v48, v50
    v_add_f32 v49, v49, v51
    v_cvt_pk_bf16_f32 v9, v48, v49
    v_lshlrev_b32 v48, 16, v34
    v_and_b32 v49, s38, v34
    v_lshlrev_b32 v50, 16, v42
    v_and_b32 v51, s38, v42
    v_mul_f32 v48, v48, v50
    v_mul_f32 v49, v49, v51
    v_cvt_pk_bf16_f32 v48, v48, v49
    v_and_b32 v49, s38, v48
    v_lshlrev_b32 v48, 16, v48
    v_lshlrev_b32 v50, 16, v10
    v_and_b32 v51, s38, v10
    v_add_f32 v48, v48, v50
    v_add_f32 v49, v49, v51
    v_cvt_pk_bf16_f32 v10, v48, v49
    v_lshlrev_b32 v48, 16, v35
    v_and_b32 v49, s38, v35
    v_lshlrev_b32 v50, 16, v43
    v_and_b32 v51, s38, v43
    v_mul_f32 v48, v48, v50
    v_mul_f32 v49, v49, v51
    v_cvt_pk_bf16_f32 v48, v48, v49
    v_and_b32 v49, s38, v48
    v_lshlrev_b32 v48, 16, v48
    v_lshlrev_b32 v50, 16, v11
    v_and_b32 v51, s38, v11
    v_add_f32 v48, v48, v50
    v_add_f32 v49, v49, v51
    v_cvt_pk_bf16_f32 v11, v48, v49
    buffer_store_dwordx4 v[8:11], v23, s[24:27], s34 offen offset:0
    v_lshlrev_b32 v48, 16, v36
    v_and_b32 v49, s38, v36
    v_lshlrev_b32 v50, 16, v44
    v_and_b32 v51, s38, v44
    v_mul_f32 v48, v48, v50
    v_mul_f32 v49, v49, v51
    v_cvt_pk_bf16_f32 v48, v48, v49
    v_and_b32 v49, s38, v48
    v_lshlrev_b32 v48, 16, v48
    v_lshlrev_b32 v50, 16, v12
    v_and_b32 v51, s38, v12
    v_add_f32 v48, v48, v50
    v_add_f32 v49, v49, v51
    v_cvt_pk_bf16_f32 v12, v48, v49
    v_lshlrev_b32 v48, 16, v37
    v_and_b32 v49, s38, v37
    v_lshlrev_b32 v50, 16, v45
    v_and_b32 v51, s38, v45
    v_mul_f32 v48, v48, v50
    v_mul_f32 v49, v49, v51
    v_cvt_pk_bf16_f32 v48, v48, v49
    v_and_b32 v49, s38, v48
    v_lshlrev_b32 v48, 16, v48
    v_lshlrev_b32 v50, 16, v13
    v_and_b32 v51, s38, v13
    v_add_f32 v48, v48, v50
    v_add_f32 v49, v49, v51
    v_cvt_pk_bf16_f32 v13, v48, v49
    v_lshlrev_b32 v48, 16, v38
    v_and_b32 v49, s38, v38
    v_lshlrev_b32 v50, 16, v46
    v_and_b32 v51, s38, v46
    v_mul_f32 v48, v48, v50
    v_mul_f32 v49, v49, v51
    v_cvt_pk_bf16_f32 v48, v48, v49
    v_and_b32 v49, s38, v48
    v_lshlrev_b32 v48, 16, v48
    v_lshlrev_b32 v50, 16, v14
    v_and_b32 v51, s38, v14
    v_add_f32 v48, v48, v50
    v_add_f32 v49, v49, v51
    v_cvt_pk_bf16_f32 v14, v48, v49
    v_lshlrev_b32 v48, 16, v39
    v_and_b32 v49, s38, v39
    v_lshlrev_b32 v50, 16, v47
    v_and_b32 v51, s38, v47
    v_mul_f32 v48, v48, v50
    v_mul_f32 v49, v49, v51
    v_cvt_pk_bf16_f32 v48, v48, v49
    v_and_b32 v49, s38, v48
    v_lshlrev_b32 v48, 16, v48
    v_lshlrev_b32 v50, 16, v15
    v_and_b32 v51, s38, v15
    v_add_f32 v48, v48, v50
    v_add_f32 v49, v49, v51
    v_cvt_pk_bf16_f32 v15, v48, v49
    buffer_store_dwordx4 v[12:15], v23, s[24:27], s34 offen offset:64
    s_add_u32 s3, s3, 160
    s_cmp_ge_u32 s3, 320
    s_cbranch_scc1 L_try_end
    s_barrier
    s_branch L_try_loop
L_try_end:
    s_endpgm
L_k3_exit:
    s_endpgm
.section .rodata,"a"
.p2align 6
.amdhsa_kernel k1_kernel
  .amdhsa_next_free_vgpr 128
  .amdhsa_next_free_sgpr 102
  .amdhsa_accum_offset 128
  .amdhsa_group_segment_fixed_size 0
  .amdhsa_kernarg_size 104
  .amdhsa_user_sgpr_count 2
  .amdhsa_user_sgpr_kernarg_segment_ptr 1
  .amdhsa_system_sgpr_workgroup_id_x 1
.end_amdhsa_kernel

.p2align 6
.amdhsa_kernel k2_kernel
  .amdhsa_next_free_vgpr 144
  .amdhsa_next_free_sgpr 102
  .amdhsa_accum_offset 144
  .amdhsa_group_segment_fixed_size 0
  .amdhsa_kernarg_size 104
  .amdhsa_user_sgpr_count 2
  .amdhsa_user_sgpr_kernarg_segment_ptr 1
  .amdhsa_system_sgpr_workgroup_id_x 1
.end_amdhsa_kernel

.p2align 6
.amdhsa_kernel k3_kernel
  .amdhsa_next_free_vgpr 168
  .amdhsa_next_free_sgpr 102
  .amdhsa_accum_offset 168
  .amdhsa_group_segment_fixed_size 0
  .amdhsa_kernarg_size 104
  .amdhsa_user_sgpr_count 2
  .amdhsa_user_sgpr_kernarg_segment_ptr 1
  .amdhsa_system_sgpr_workgroup_id_x 1
.end_amdhsa_kernel
```
